```python
import torch

def _softmax(x, axis=-1):
    return torch.softmax(x, dim=axis)
def _gelu(x):
    return torch.nn.functional.gelu(x, approximate="tanh")
def _silu(x):
    return torch.nn.functional.silu(x)
def _sigmoid(x):
    return torch.sigmoid(x)
def _layernorm(x, axis=-1, eps=1e-5):
    m = x.mean(dim=axis, keepdim=True)
    v = x.var(dim=axis, keepdim=True, unbiased=False)
    return (x - m) / torch.sqrt(v + eps)
def _scatter_add(tgt, idx, src, axis=0):
    return tgt.clone().index_add_(axis, idx, src)
def _segment_sum(src, seg, n):
    out = torch.zeros((n,) + src.shape[1:], dtype=src.dtype)
    return out.index_add_(0, seg, src)
def _pad(x, pw):
    flat = tuple(v for pair in reversed(pw) for v in pair)
    return torch.nn.functional.pad(x, flat)

kernel_name = 'standalone__grouped_kv_mqa__prompt'

def setup_inputs():

    _w = (lambda a: (lambda t: t.to(torch.bfloat16) if t.is_floating_point() else t)(torch.as_tensor(a)))
    B, S, D, H = 1, 2048, 576, 32
    Dh = D // H
    return {
        "x": _w((lambda *s: torch.randn(*s, dtype=torch.bfloat16) * 0.05)(B, S, D)),
        "wq": _w((lambda *s: torch.randn(*s, dtype=torch.bfloat16) * 0.8)(D, H * Dh)),
        "wk": _w((lambda *s: torch.randn(*s, dtype=torch.bfloat16) * 0.8)(D, Dh)),
        "wv": _w((lambda *s: torch.randn(*s, dtype=torch.bfloat16) * 0.05)(D, Dh)),
        "wo": _w((lambda *s: torch.randn(*s, dtype=torch.bfloat16) * 0.05)(H * Dh, D)),
    }

def reference(x, wq, wk, wv, wo):
    B, S, D = x.shape
    H = 32
    Dh = D // H
    q = (lambda x, *d: x.permute(*d))((x @ wq).reshape(B, S, H, Dh), 0, 2, 1, 3)
    k = x @ wk
    v = x @ wv
    scores = torch.einsum("bhqd,bkd->bhqk", q, k) * (Dh ** -0.5)
    p = _softmax(scores, axis=-1)
    o = torch.einsum("bhqk,bkd->bhqd", p, v)
    return (lambda x, *d: x.permute(*d))(o, 0, 2, 1, 3).reshape(B, S, H * Dh) @ wo
```

```asm
; @launch grid=(256,1,1) block=(512,1,1) lds=163840
.amdgcn_target "amdgcn-amd-amdhsa--gfx950"
.text
.globl standalone__grouped_kv_mqa__prompt_kernel
.p2align 8
.type standalone__grouped_kv_mqa__prompt_kernel,@function
standalone__grouped_kv_mqa__prompt_kernel:
    s_setprio 3
    s_cmp_ge_u32 s2, 256
    s_cbranch_scc1 L_exit_f
    s_load_dwordx2 s[8:9], s[0:1], 0
    s_load_dwordx2 s[12:13], s[0:1], 8
    s_load_dwordx4 s[40:43], s[0:1], 16
    s_load_dwordx2 s[28:29], s[0:1], 56
    s_load_dwordx2 s[20:21], s[0:1], 32
    s_load_dwordx2 s[24:25], s[0:1], 40
    v_lshrrev_b32 v12, 6, v0
    v_and_b32 v1, 63, v0
    v_readfirstlane_b32 s3, v12
    s_and_b32 s4, s2, 7
    s_lshl_b32 s4, s4, 2
    s_lshr_b32 s5, s2, 6
    s_add_u32 s4, s4, s5
    s_bfe_u32 s5, s2, 0x30003
    s_mov_b32 s10, 2359296
    s_mov_b32 s11, 0x20000
    s_and_b32 s34, s3, 1
    s_lshl_b32 s34, s34, 2
    v_lshrrev_b32 v12, 4, v1
    v_add_u32 v12, s34, v12
    v_xor_b32 v12, v12, v1
    v_and_b32 v12, 7, v12
    v_lshrrev_b32 v13, 3, v1
    v_mul_u32_u24 v13, 1152, v13
    v_lshl_add_u32 v2, v12, 4, v13
    v_lshlrev_b32 v5, 4, v1
    s_cmp_ge_u32 s3, 4
    s_cbranch_scc1 L_roleC
    s_cmp_ge_u32 s3, 2
    s_cbranch_scc1 L_roleL
    s_and_b32 s34, s5, 6
    s_and_b32 s35, s3, 1
    s_add_u32 s34, s34, s35
    s_add_u32 s34, s34, 0
    s_and_b32 s34, s34, 7
    s_mul_i32 s62, s34, 9216
    s_mul_i32 s35, s4, 73728
    s_add_u32 s62, s62, s35
    s_lshr_b32 s35, s34, 2
    s_mul_i32 s35, s35, 32768
    s_lshl_b32 s63, s34, 10
    s_add_u32 s63, s63, s35
    s_add_u32 s63, s63, 88704
    s_bitcmp1_b32 s5, 0
    s_waitcnt lgkmcnt(0)
    s_add_u32 m0, s63, 0
    s_nop 0
    buffer_load_dwordx4 v2, s[8:11], s62 offen offset:0 lds
    s_add_u32 m0, s63, 3968
    s_nop 0
    buffer_load_dwordx4 v2, s[8:11], s62 offen offset:128 lds
    s_add_u32 m0, s63, 7936
    s_nop 0
    buffer_load_dwordx4 v2, s[8:11], s62 offen offset:256 lds
    s_add_u32 m0, s63, 11904
    s_nop 0
    buffer_load_dwordx4 v2, s[8:11], s62 offen offset:384 lds
    s_add_u32 m0, s63, 15872
    s_nop 0
    buffer_load_dwordx4 v2, s[8:11], s62 offen offset:512 lds
    s_add_u32 m0, s63, 19840
    s_nop 0
    buffer_load_dwordx4 v2, s[8:11], s62 offen offset:640 lds
    s_add_u32 m0, s63, 23808
    s_nop 0
    buffer_load_dwordx4 v2, s[8:11], s62 offen offset:768 lds
    s_add_u32 m0, s63, 27776
    s_nop 0
    buffer_load_dwordx4 v2, s[8:11], s62 offen offset:896 lds
    s_add_u32 m0, s63, 31744
    s_nop 0
    buffer_load_dwordx4 v2, s[8:11], s62 offen offset:1024 lds
    s_load_dwordx2 s[64:65], s[28:29], 253952
    s_and_b32 s6, s3, 3
    s_lshr_b32 s7, s3, 2
    v_mul_u32_u24 v12, 27, v1
    v_lshrrev_b32 v12, 9, v12
    v_mul_u32_u24 v13, 19, v12
    v_sub_u32 v13, v1, v13
    v_mul_u32_u24 v12, 2304, v12
    v_lshl_add_u32 v12, v13, 4, v12
    v_cmp_le_u32 vcc, 9, v13
    v_add_u32 v13, 1008, v12
    s_mov_b32 s14, 663552
    v_cndmask_b32 v175, v12, v13, vcc
    s_mov_b32 s15, 0x20000
    s_mov_b32 s30, 2621440
    s_mov_b32 s31, 0x20000
    s_mov_b32 s22, 663552
    s_mov_b32 s23, 0x20000
    s_mov_b32 s26, 2359296
    s_mov_b32 s27, 0x20000
    v_mov_b32 v137, 0
    v_mov_b32 v138, 0
    v_and_b32 v12, 31, v1
    v_lshrrev_b32 v14, 5, v1
    v_mul_u32_u24 v14, 304, v14
    v_lshl_add_u32 v14, v12, 4, v14
    v_cmp_lt_u32 vcc, 18, v12
    s_mul_i32 s34, s7, 4864
    s_add_u32 s34, s34, 9216
    v_add_u32 v165, s34, v14
    v_mov_b32 v13, 0x40000
    v_cndmask_b32 v165, v165, v13, vcc
    s_lshl_b32 s34, s7, 12
    v_add_u32 v164, s34, v5
    s_lshl_b32 s34, s7, 3
    s_add_u32 s34, s34, 8192
    v_add_u32 v166, s34, v5
    v_mul_u32_u24 v12, 57, v1
    v_lshrrev_b32 v12, 9, v12
    v_mul_u32_u24 v12, 1008, v12
    v_add_u32 v3, v12, v5
    s_lshr_b32 s34, s4, 2
    s_add_u32 s34, s34, s3
    s_add_u32 s34, s34, 1
    s_and_b32 s34, s34, 7
    s_mul_i32 s58, s34, 19456
    s_lshl_b32 s34, s34, 10
    s_add_u32 s57, s34, 196608
    s_mul_i32 s59, s3, 19456
    s_lshl_b32 s34, s3, 10
    s_add_u32 s34, s34, 155648
    v_add_u32 v84, s34, v5
    s_lshr_b32 s34, s6, 1
    s_mul_i32 s34, s34, 18944
    s_lshl_b32 s35, s6, 8
    s_add_u32 s34, s34, s35
    s_add_u32 s34, s34, 18944
    v_lshl_add_u32 v86, v1, 2, s34
    s_lshl_b32 s35, s7, 7
    v_add_u32 v85, s35, v86
    v_xor_b32 v86, s35, v86
    s_xor_b32 s34, s3, 4
    s_lshl_b32 s34, s34, 10
    s_add_u32 s34, s34, 155648
    v_add_u32 v87, s34, v5
    s_lshr_b32 s52, s5, 1
    s_lshr_b32 s53, s52, 1
    s_mul_i32 s34, s53, 36864
    s_add_u32 s34, s34, 88704
    s_and_b32 s54, s52, 1
    s_lshl_b32 s35, s54, 4
    v_and_b32 v179, 15, v1
    v_add_u32 v12, s35, v179
    v_lshrrev_b32 v13, 1, v12
    v_lshrrev_b32 v180, 4, v1
    v_xor_b32 v13, v13, v180
    v_and_b32 v13, 7, v13
    v_lshlrev_b32 v13, 4, v13
    v_lshl_add_u32 v13, v12, 7, v13
    v_add_u32 v176, s34, v13
    v_xor_b32 v177, 64, v176
    v_bfe_u32 v13, v1, 2, 2
    v_lshl_add_u32 v13, v180, 3, v13
    v_mul_u32_u24 v13, 48, v13
    v_and_b32 v14, 3, v1
    v_lshlrev_b32 v14, 3, v14
    s_cmp_eq_u32 s3, 0
    s_cselect_b32 s35, -1, 0
    s_cselect_b32 s34, 0, 32
    s_add_u32 s34, s34, 60192
    v_and_b32 v14, s35, v14
    v_add3_u32 v178, v13, v14, s34
    s_waitcnt vmcnt(0) lgkmcnt(0)
    s_barrier
    s_bitcmp1_b32 s5, 0
    s_cbranch_scc1 L_kvV_f
    ds_read_b64_tr_b16 v[184:185], v178 offset:0
    ds_read_b64_tr_b16 v[186:187], v178 offset:192
    ds_read_b128 v[188:191], v176 offset:0
    ds_read_b64_tr_b16 v[192:193], v178 offset:1536
    ds_read_b64_tr_b16 v[194:195], v178 offset:1728
    ds_read_b128 v[196:199], v177 offset:0
    ds_read_b64_tr_b16 v[200:201], v178 offset:3072
    ds_read_b64_tr_b16 v[202:203], v178 offset:3264
    ds_read_b128 v[204:207], v176 offset:4096
    ds_read_b64_tr_b16 v[208:209], v178 offset:4608
    ds_read_b64_tr_b16 v[210:211], v178 offset:4800
    ds_read_b128 v[212:215], v177 offset:4096
    s_waitcnt lgkmcnt(9)
    v_mfma_f32_16x16x32_bf16 v[216:219], v[184:187], v[188:191], 0
    ds_read_b64_tr_b16 v[184:185], v178 offset:6144
    ds_read_b64_tr_b16 v[186:187], v178 offset:6336
    ds_read_b128 v[188:191], v176 offset:8192
    s_waitcnt lgkmcnt(9)
    v_mfma_f32_16x16x32_bf16 v[216:219], v[192:195], v[196:199], v[216:219]
    ds_read_b64_tr_b16 v[192:193], v178 offset:7680
    ds_read_b64_tr_b16 v[194:195], v178 offset:7872
    ds_read_b128 v[196:199], v177 offset:8192
    s_waitcnt lgkmcnt(9)
    v_mfma_f32_16x16x32_bf16 v[216:219], v[200:203], v[204:207], v[216:219]
    ds_read_b64_tr_b16 v[200:201], v178 offset:9216
    ds_read_b64_tr_b16 v[202:203], v178 offset:9408
    ds_read_b128 v[204:207], v176 offset:12288
    s_waitcnt lgkmcnt(9)
    v_mfma_f32_16x16x32_bf16 v[216:219], v[208:211], v[212:215], v[216:219]
    ds_read_b64_tr_b16 v[208:209], v178 offset:10752
    ds_read_b64_tr_b16 v[210:211], v178 offset:10944
    ds_read_b128 v[212:215], v177 offset:12288
    s_waitcnt lgkmcnt(9)
    v_mfma_f32_16x16x32_bf16 v[216:219], v[184:187], v[188:191], v[216:219]
    ds_read_b64_tr_b16 v[184:185], v178 offset:12288
    ds_read_b64_tr_b16 v[186:187], v178 offset:12480
    ds_read_b128 v[188:191], v176 offset:16384
    s_waitcnt lgkmcnt(9)
    v_mfma_f32_16x16x32_bf16 v[216:219], v[192:195], v[196:199], v[216:219]
    ds_read_b64_tr_b16 v[192:193], v178 offset:13824
    ds_read_b64_tr_b16 v[194:195], v178 offset:14016
    ds_read_b128 v[196:199], v177 offset:16384
    s_waitcnt lgkmcnt(9)
    v_mfma_f32_16x16x32_bf16 v[216:219], v[200:203], v[204:207], v[216:219]
    ds_read_b64_tr_b16 v[200:201], v178 offset:15360
    ds_read_b64_tr_b16 v[202:203], v178 offset:15552
    ds_read_b128 v[204:207], v176 offset:20480
    s_waitcnt lgkmcnt(9)
    v_mfma_f32_16x16x32_bf16 v[216:219], v[208:211], v[212:215], v[216:219]
    ds_read_b64_tr_b16 v[208:209], v178 offset:16896
    ds_read_b64_tr_b16 v[210:211], v178 offset:17088
    ds_read_b128 v[212:215], v177 offset:20480
    s_waitcnt lgkmcnt(9)
    v_mfma_f32_16x16x32_bf16 v[216:219], v[184:187], v[188:191], v[216:219]
    ds_read_b64_tr_b16 v[184:185], v178 offset:18432
    ds_read_b64_tr_b16 v[186:187], v178 offset:18624
    ds_read_b128 v[188:191], v176 offset:24576
    s_waitcnt lgkmcnt(9)
    v_mfma_f32_16x16x32_bf16 v[216:219], v[192:195], v[196:199], v[216:219]
    ds_read_b64_tr_b16 v[192:193], v178 offset:19968
    ds_read_b64_tr_b16 v[194:195], v178 offset:20160
    ds_read_b128 v[196:199], v177 offset:24576
    s_waitcnt lgkmcnt(9)
    v_mfma_f32_16x16x32_bf16 v[216:219], v[200:203], v[204:207], v[216:219]
    ds_read_b64_tr_b16 v[200:201], v178 offset:21504
    ds_read_b64_tr_b16 v[202:203], v178 offset:21696
    ds_read_b128 v[204:207], v176 offset:28672
    s_waitcnt lgkmcnt(9)
    v_mfma_f32_16x16x32_bf16 v[216:219], v[208:211], v[212:215], v[216:219]
    ds_read_b64_tr_b16 v[208:209], v178 offset:23040
    ds_read_b64_tr_b16 v[210:211], v178 offset:23232
    ds_read_b128 v[212:215], v177 offset:28672
    s_waitcnt lgkmcnt(9)
    v_mfma_f32_16x16x32_bf16 v[216:219], v[184:187], v[188:191], v[216:219]
    ds_read_b64_tr_b16 v[184:185], v178 offset:24576
    ds_read_b64_tr_b16 v[186:187], v178 offset:24768
    ds_read_b128 v[188:191], v176 offset:32768
    s_waitcnt lgkmcnt(9)
    v_mfma_f32_16x16x32_bf16 v[216:219], v[192:195], v[196:199], v[216:219]
    ds_read_b64_tr_b16 v[192:193], v178 offset:26112
    ds_read_b64_tr_b16 v[194:195], v178 offset:26304
    ds_read_b128 v[196:199], v177 offset:32768
    s_waitcnt lgkmcnt(9)
    v_mfma_f32_16x16x32_bf16 v[216:219], v[200:203], v[204:207], v[216:219]
    s_waitcnt lgkmcnt(6)
    v_mfma_f32_16x16x32_bf16 v[216:219], v[208:211], v[212:215], v[216:219]
    s_waitcnt lgkmcnt(3)
    v_mfma_f32_16x16x32_bf16 v[216:219], v[184:187], v[188:191], v[216:219]
    s_waitcnt lgkmcnt(0)
    v_mfma_f32_16x16x32_bf16 v[216:219], v[192:195], v[196:199], v[216:219]
    s_lshr_b32 s55, s4, 2
    s_mul_i32 s55, s55, 19456
    s_and_b32 s56, s4, 3
    s_lshl_b32 s56, s56, 1
    s_add_u32 s56, s56, s53
    s_lshl_b32 s35, s54, 4
    v_add_u32 v12, s35, v179
    s_cmp_lg_u32 s3, 0
    s_cbranch_scc1 L_kvKhi_f
    s_lshl_b32 s34, s56, 10
    s_add_u32 s55, s55, s34
    v_lshrrev_b32 v13, 1, v180
    v_lshl_add_u32 v12, v13, 5, v12
    v_lshlrev_b32 v12, 4, v12
    v_and_b32 v13, 1, v180
    v_lshl_add_u32 v12, v13, 3, v12
    v_cvt_pk_bf16_f32 v220, v216, v217
    v_cvt_pk_bf16_f32 v221, v218, v219
    buffer_store_dwordx2 v[220:221], v12, s[28:31], s55 offen sc1
    s_branch L_kvdone_f
L_kvKhi_f:
    s_and_b32 s34, s56, 1
    s_lshl_b32 s34, s34, 9
    s_lshr_b32 s35, s56, 1
    s_lshl_b32 s35, s35, 2
    s_add_u32 s34, s34, s35
    s_add_u32 s55, s55, s34
    s_add_u32 s55, s55, 8192
    v_lshlrev_b32 v12, 4, v12
    v_cvt_pk_bf16_f32 v220, v216, v217
    s_mov_b64 exec, 0xffff
    buffer_store_dword v220, v12, s[28:31], s55 offen sc1
    s_mov_b64 exec, -1
    s_branch L_kvdone_f
L_kvV_f:
    ds_read_b64_tr_b16 v[184:185], v178 offset:0
    ds_read_b64_tr_b16 v[186:187], v178 offset:192
    ds_read_b128 v[188:191], v176 offset:0
    ds_read_b64_tr_b16 v[192:193], v178 offset:1536
    ds_read_b64_tr_b16 v[194:195], v178 offset:1728
    ds_read_b128 v[196:199], v177 offset:0
    ds_read_b64_tr_b16 v[200:201], v178 offset:3072
    ds_read_b64_tr_b16 v[202:203], v178 offset:3264
    ds_read_b128 v[204:207], v176 offset:4096
    ds_read_b64_tr_b16 v[208:209], v178 offset:4608
    ds_read_b64_tr_b16 v[210:211], v178 offset:4800
    ds_read_b128 v[212:215], v177 offset:4096
    s_waitcnt lgkmcnt(9)
    v_mfma_f32_16x16x32_bf16 v[216:219], v[188:191], v[184:187], 0
    ds_read_b64_tr_b16 v[184:185], v178 offset:6144
    ds_read_b64_tr_b16 v[186:187], v178 offset:6336
    ds_read_b128 v[188:191], v176 offset:8192
    s_waitcnt lgkmcnt(9)
    v_mfma_f32_16x16x32_bf16 v[216:219], v[196:199], v[192:195], v[216:219]
    ds_read_b64_tr_b16 v[192:193], v178 offset:7680
    ds_read_b64_tr_b16 v[194:195], v178 offset:7872
    ds_read_b128 v[196:199], v177 offset:8192
    s_waitcnt lgkmcnt(9)
    v_mfma_f32_16x16x32_bf16 v[216:219], v[204:207], v[200:203], v[216:219]
    ds_read_b64_tr_b16 v[200:201], v178 offset:9216
    ds_read_b64_tr_b16 v[202:203], v178 offset:9408
    ds_read_b128 v[204:207], v176 offset:12288
    s_waitcnt lgkmcnt(9)
    v_mfma_f32_16x16x32_bf16 v[216:219], v[212:215], v[208:211], v[216:219]
    ds_read_b64_tr_b16 v[208:209], v178 offset:10752
    ds_read_b64_tr_b16 v[210:211], v178 offset:10944
    ds_read_b128 v[212:215], v177 offset:12288
    s_waitcnt lgkmcnt(9)
    v_mfma_f32_16x16x32_bf16 v[216:219], v[188:191], v[184:187], v[216:219]
    ds_read_b64_tr_b16 v[184:185], v178 offset:12288
    ds_read_b64_tr_b16 v[186:187], v178 offset:12480
    ds_read_b128 v[188:191], v176 offset:16384
    s_waitcnt lgkmcnt(9)
    v_mfma_f32_16x16x32_bf16 v[216:219], v[196:199], v[192:195], v[216:219]
    ds_read_b64_tr_b16 v[192:193], v178 offset:13824
    ds_read_b64_tr_b16 v[194:195], v178 offset:14016
    ds_read_b128 v[196:199], v177 offset:16384
    s_waitcnt lgkmcnt(9)
    v_mfma_f32_16x16x32_bf16 v[216:219], v[204:207], v[200:203], v[216:219]
    ds_read_b64_tr_b16 v[200:201], v178 offset:15360
    ds_read_b64_tr_b16 v[202:203], v178 offset:15552
    ds_read_b128 v[204:207], v176 offset:20480
    s_waitcnt lgkmcnt(9)
    v_mfma_f32_16x16x32_bf16 v[216:219], v[212:215], v[208:211], v[216:219]
    ds_read_b64_tr_b16 v[208:209], v178 offset:16896
    ds_read_b64_tr_b16 v[210:211], v178 offset:17088
    ds_read_b128 v[212:215], v177 offset:20480
    s_waitcnt lgkmcnt(9)
    v_mfma_f32_16x16x32_bf16 v[216:219], v[188:191], v[184:187], v[216:219]
    ds_read_b64_tr_b16 v[184:185], v178 offset:18432
    ds_read_b64_tr_b16 v[186:187], v178 offset:18624
    ds_read_b128 v[188:191], v176 offset:24576
    s_waitcnt lgkmcnt(9)
    v_mfma_f32_16x16x32_bf16 v[216:219], v[196:199], v[192:195], v[216:219]
    ds_read_b64_tr_b16 v[192:193], v178 offset:19968
    ds_read_b64_tr_b16 v[194:195], v178 offset:20160
    ds_read_b128 v[196:199], v177 offset:24576
    s_waitcnt lgkmcnt(9)
    v_mfma_f32_16x16x32_bf16 v[216:219], v[204:207], v[200:203], v[216:219]
    ds_read_b64_tr_b16 v[200:201], v178 offset:21504
    ds_read_b64_tr_b16 v[202:203], v178 offset:21696
    ds_read_b128 v[204:207], v176 offset:28672
    s_waitcnt lgkmcnt(9)
    v_mfma_f32_16x16x32_bf16 v[216:219], v[212:215], v[208:211], v[216:219]
    ds_read_b64_tr_b16 v[208:209], v178 offset:23040
    ds_read_b64_tr_b16 v[210:211], v178 offset:23232
    ds_read_b128 v[212:215], v177 offset:28672
    s_waitcnt lgkmcnt(9)
    v_mfma_f32_16x16x32_bf16 v[216:219], v[188:191], v[184:187], v[216:219]
    ds_read_b64_tr_b16 v[184:185], v178 offset:24576
    ds_read_b64_tr_b16 v[186:187], v178 offset:24768
    ds_read_b128 v[188:191], v176 offset:32768
    s_waitcnt lgkmcnt(9)
    v_mfma_f32_16x16x32_bf16 v[216:219], v[196:199], v[192:195], v[216:219]
    ds_read_b64_tr_b16 v[192:193], v178 offset:26112
    ds_read_b64_tr_b16 v[194:195], v178 offset:26304
    ds_read_b128 v[196:199], v177 offset:32768
    s_waitcnt lgkmcnt(9)
    v_mfma_f32_16x16x32_bf16 v[216:219], v[204:207], v[200:203], v[216:219]
    s_waitcnt lgkmcnt(6)
    v_mfma_f32_16x16x32_bf16 v[216:219], v[212:215], v[208:211], v[216:219]
    s_waitcnt lgkmcnt(3)
    v_mfma_f32_16x16x32_bf16 v[216:219], v[188:191], v[184:187], v[216:219]
    s_waitcnt lgkmcnt(0)
    v_mfma_f32_16x16x32_bf16 v[216:219], v[196:199], v[192:195], v[216:219]
    s_lshr_b32 s55, s4, 2
    s_mul_i32 s55, s55, 19456
    s_and_b32 s56, s4, 3
    s_lshl_b32 s56, s56, 1
    s_add_u32 s56, s56, s53
    s_mul_i32 s34, s56, 1216
    s_mul_i32 s35, s54, 608
    s_add_u32 s55, s55, s34
    s_add_u32 s55, s55, s35
    s_add_u32 s55, s55, 9216
    v_mov_b32 v12, v179
    s_cmp_eq_u32 s3, 0
    s_cselect_b32 s34, 0, 16
    s_cselect_b32 s32, -1, 0x00070007
    s_cselect_b32 s33, -1, 0x00070007
    v_add_u32 v12, s34, v12
    v_lshlrev_b32 v12, 4, v12
    v_and_b32 v13, 1, v180
    v_mul_u32_u24 v13, 304, v13
    v_add_u32 v12, v12, v13
    v_lshrrev_b32 v13, 1, v180
    v_lshl_add_u32 v12, v13, 3, v12
    v_cvt_pk_bf16_f32 v220, v216, v217
    v_cvt_pk_bf16_f32 v221, v218, v219
    s_cmp_eq_u32 s3, 0
    s_cbranch_scc1 L_kvnoone
    s_mov_b32 exec_lo, 0x00040004
    s_mov_b32 exec_hi, 0x00040004
    v_mov_b32 v220, 0x3f803f80
    v_mov_b32 v221, 0x3f803f80
L_kvnoone:
    s_mov_b64 exec, s[32:33]
    buffer_store_dwordx2 v[220:221], v12, s[28:31], s55 offen sc1
    s_mov_b64 exec, -1
L_kvdone_f:
    s_and_b32 s34, s5, 6
    s_and_b32 s35, s3, 1
    s_add_u32 s34, s34, s35
    s_add_u32 s34, s34, 2
    s_and_b32 s34, s34, 7
    s_mul_i32 s52, s34, 9216
    s_mul_i32 s35, s4, 73728
    s_add_u32 s52, s52, s35
    s_lshr_b32 s35, s34, 2
    s_mul_i32 s35, s35, 32768
    s_lshl_b32 s53, s34, 10
    s_add_u32 s53, s53, s35
    s_add_u32 s53, s53, 88704
    s_lshr_b32 s34, s3, 1
    s_lshl_b32 s35, s34, 7
    s_add_u32 s52, s52, s35
    s_lshl_b32 s35, s34, 12
    s_add_u32 s53, s53, s35
    s_and_b32 s34, s5, 6
    s_and_b32 s35, s3, 1
    s_add_u32 s34, s34, s35
    s_add_u32 s34, s34, 4
    s_and_b32 s34, s34, 7
    s_mul_i32 s54, s34, 9216
    s_mul_i32 s35, s4, 73728
    s_add_u32 s54, s54, s35
    s_lshr_b32 s35, s34, 2
    s_mul_i32 s35, s35, 32768
    s_lshl_b32 s55, s34, 10
    s_add_u32 s55, s55, s35
    s_add_u32 s55, s55, 88704
    s_lshr_b32 s34, s3, 1
    s_lshl_b32 s35, s34, 7
    s_add_u32 s54, s54, s35
    s_lshl_b32 s35, s34, 12
    s_add_u32 s55, s55, s35
    s_and_b32 s34, s5, 6
    s_and_b32 s35, s3, 1
    s_add_u32 s34, s34, s35
    s_add_u32 s34, s34, 6
    s_and_b32 s34, s34, 7
    s_mul_i32 s62, s34, 9216
    s_mul_i32 s35, s4, 73728
    s_add_u32 s62, s62, s35
    s_lshr_b32 s35, s34, 2
    s_mul_i32 s35, s35, 32768
    s_lshl_b32 s63, s34, 10
    s_add_u32 s63, s63, s35
    s_add_u32 s63, s63, 88704
    s_lshr_b32 s34, s3, 1
    s_lshl_b32 s35, s34, 7
    s_add_u32 s62, s62, s35
    s_lshl_b32 s35, s34, 12
    s_add_u32 s63, s63, s35
    s_mul_i32 s60, s3, 6912
    s_mul_i32 s35, s5, 144
    s_add_u32 s60, s60, s35
    s_add_u32 s60, s60, 331776
    s_mul_i32 s94, s3, 912
    s_mov_b32 s92, 0xfffbffff
    s_mov_b32 s93, 0xffffdf
    s_barrier
    s_add_u32 m0, s53, 19840
    s_nop 0
    buffer_load_dwordx4 v2, s[8:11], s52 offen offset:640 lds
    s_add_u32 m0, s55, 19840
    s_nop 0
    buffer_load_dwordx4 v2, s[8:11], s54 offen offset:640 lds
    s_add_u32 m0, s63, 19840
    s_nop 0
    buffer_load_dwordx4 v2, s[8:11], s62 offen offset:640 lds
    s_mov_b64 exec, s[92:93]
    s_add_u32 m0, s94, 43776
    s_add_u32 s60, s60, 0
    buffer_load_dwordx4 v175, s[12:15], s60 offen lds
    s_add_u32 m0, s94, 47424
    s_add_u32 s60, s60, 27648
    buffer_load_dwordx4 v175, s[12:15], s60 offen lds
    s_add_u32 m0, s94, 51072
    s_add_u32 s60, s60, 27648
    buffer_load_dwordx4 v175, s[12:15], s60 offen lds
    s_add_u32 m0, s94, 54720
    s_add_u32 s60, s60, 27648
    buffer_load_dwordx4 v175, s[12:15], s60 offen lds
    s_add_u32 m0, s94, 58368
    s_add_u32 s60, s60, 27648
    buffer_load_dwordx4 v175, s[12:15], s60 offen lds
    s_add_u32 m0, s94, 62016
    s_add_u32 s60, s60, 27648
    buffer_load_dwordx4 v175, s[12:15], s60 offen lds
    s_mov_b64 exec, -1
    s_and_b32 s34, s2, 7
    s_lshl_b32 s34, s34, 10
    s_lshr_b32 s35, s2, 3
    s_lshl_b32 s35, s35, 5
    s_add_u32 s34, s34, s35
    s_lshl_b32 s35, s3, 3
    s_add_u32 s34, s34, s35
    s_add_u32 s34, s34, 196608
    s_waitcnt vmcnt(9)
    s_waitcnt lgkmcnt(0)
    s_add_u32 s64, s64, 0x7f4a7c15
    s_addc_u32 s65, s65, 0x9e3779b9
    v_mov_b32 v172, s64
    v_mov_b32 v173, s65
    v_mov_b32 v12, 0
    s_mov_b64 exec, 1
    buffer_store_dwordx2 v[172:173], v12, s[28:31], s34 offen sc1
    s_mov_b64 exec, -1
    s_barrier
    s_add_u32 m0, s53, 27776
    s_nop 0
    buffer_load_dwordx4 v2, s[8:11], s52 offen offset:896 lds
    s_add_u32 m0, s55, 27776
    s_nop 0
    buffer_load_dwordx4 v2, s[8:11], s54 offen offset:896 lds
    s_add_u32 m0, s63, 27776
    s_nop 0
    buffer_load_dwordx4 v2, s[8:11], s62 offen offset:896 lds
    s_mov_b64 exec, s[92:93]
    s_add_u32 m0, s94, 65664
    s_add_u32 s60, s60, 27648
    buffer_load_dwordx4 v175, s[12:15], s60 offen lds
    s_add_u32 m0, s94, 69312
    s_add_u32 s60, s60, 27648
    buffer_load_dwordx4 v175, s[12:15], s60 offen lds
    s_add_u32 m0, s94, 72960
    s_add_u32 s60, s60, 27648
    buffer_load_dwordx4 v175, s[12:15], s60 offen lds
    s_add_u32 m0, s94, 76608
    s_add_u32 s60, s60, 27648
    buffer_load_dwordx4 v175, s[12:15], s60 offen lds
    s_add_u32 m0, s94, 80256
    s_add_u32 s60, s60, 27648
    buffer_load_dwordx4 v175, s[12:15], s60 offen lds
    s_add_u32 m0, s94, 83904
    s_add_u32 s60, s60, 27648
    buffer_load_dwordx4 v175, s[12:15], s60 offen lds
    s_mov_b64 exec, -1
    s_waitcnt vmcnt(10)
    s_barrier
    v_and_b32 v180, 31, v1
    v_lshlrev_b32 v180, 5, v180
    buffer_load_dwordx4 v[176:179], v180, s[28:31], s57 offen sc1
    s_waitcnt vmcnt(1)
    s_barrier
    s_mov_b32 s56, 0
    s_waitcnt vmcnt(0)
L_poll_a:
    v_cmp_ne_u64 vcc, v[176:177], v[172:173]
    v_cmp_ne_u64 s[32:33], v[178:179], v[172:173]
    s_or_b64 vcc, vcc, s[32:33]
    s_cbranch_vccz L_pollok_a
    s_add_u32 s56, s56, 1
    s_bitcmp1_b32 s56, 18
    s_cbranch_scc1 L_pollok_a
    buffer_load_dwordx4 v[176:179], v180, s[28:31], s57 offen sc1
    s_waitcnt vmcnt(0)
    s_branch L_poll_a
L_pollok_a:
    s_add_u32 m0, s59, 0
    s_add_u32 s55, s58, 0
    buffer_load_dwordx4 v5, s[28:31], s55 offen offset:0 sc1 lds
    buffer_load_dwordx4 v5, s[28:31], s55 offen offset:1024 sc1 lds
    buffer_load_dwordx4 v5, s[28:31], s55 offen offset:2048 sc1 lds
    buffer_load_dwordx4 v5, s[28:31], s55 offen offset:3072 sc1 lds
    s_add_u32 m0, s59, 4096
    s_add_u32 s55, s58, 4096
    buffer_load_dwordx4 v5, s[28:31], s55 offen offset:0 sc1 lds
    buffer_load_dwordx4 v5, s[28:31], s55 offen offset:1024 sc1 lds
    buffer_load_dwordx4 v5, s[28:31], s55 offen offset:2048 sc1 lds
    buffer_load_dwordx4 v5, s[28:31], s55 offen offset:3072 sc1 lds
    s_add_u32 m0, s59, 8192
    s_add_u32 s55, s58, 8192
    buffer_load_dwordx4 v5, s[28:31], s55 offen offset:0 sc1 lds
    buffer_load_dwordx4 v5, s[28:31], s55 offen offset:1024 sc1 lds
    buffer_load_dwordx4 v5, s[28:31], s55 offen offset:2048 sc1 lds
    buffer_load_dwordx4 v5, s[28:31], s55 offen offset:3072 sc1 lds
    s_add_u32 m0, s59, 12288
    s_add_u32 s55, s58, 12288
    buffer_load_dwordx4 v5, s[28:31], s55 offen offset:0 sc1 lds
    buffer_load_dwordx4 v5, s[28:31], s55 offen offset:1024 sc1 lds
    buffer_load_dwordx4 v5, s[28:31], s55 offen offset:2048 sc1 lds
    buffer_load_dwordx4 v5, s[28:31], s55 offen offset:3072 sc1 lds
    s_add_u32 m0, s59, 16384
    s_add_u32 s55, s58, 16384
    buffer_load_dwordx4 v5, s[28:31], s55 offen offset:0 sc1 lds
    buffer_load_dwordx4 v5, s[28:31], s55 offen offset:1024 sc1 lds
    s_mov_b32 exec_hi, 0
    buffer_load_dwordx4 v5, s[28:31], s55 offen offset:2048 sc1 lds
    s_mov_b32 exec_hi, -1
    s_setprio 0
    s_barrier
    s_branch L_qb
L_roleL:
    v_mul_u32_u24 v12, 171, v1
    v_lshrrev_b32 v12, 9, v12
    v_mul_u32_u24 v12, 12, v12
    v_sub_u32 v4, v5, v12
    s_mov_b32 s18, 20736
    s_mov_b32 s19, 0x20000
    s_and_b32 s6, s3, 3
    s_lshr_b32 s7, s3, 2
    v_mul_u32_u24 v12, 27, v1
    v_lshrrev_b32 v12, 9, v12
    v_mul_u32_u24 v13, 19, v12
    v_sub_u32 v13, v1, v13
    v_mul_u32_u24 v12, 2304, v12
    v_lshl_add_u32 v12, v13, 4, v12
    v_cmp_le_u32 vcc, 9, v13
    v_add_u32 v13, 1008, v12
    s_mov_b32 s14, 663552
    v_cndmask_b32 v175, v12, v13, vcc
    s_mov_b32 s15, 0x20000
    s_mov_b32 s30, 2621440
    s_mov_b32 s31, 0x20000
    s_mov_b32 s22, 663552
    s_mov_b32 s23, 0x20000
    s_mov_b32 s26, 2359296
    s_mov_b32 s27, 0x20000
    s_bitcmp1_b32 s5, 0
    s_waitcnt lgkmcnt(0)
    s_cselect_b32 s16, s42, s40
    s_cselect_b32 s17, s43, s41
    s_sub_u32 s33, s3, 2
    s_mul_i32 s34, s33, 5292
    s_mul_i32 s35, s33, 7056
    s_mov_b32 exec_hi, 0x7fffffff
    s_add_u32 m0, s35, 60192
    s_add_u32 s34, s34, 0
    buffer_load_dwordx4 v4, s[16:19], s34 offen lds
    s_add_u32 m0, s35, 61200
    s_add_u32 s34, s34, 756
    buffer_load_dwordx4 v4, s[16:19], s34 offen lds
    s_add_u32 m0, s35, 62208
    s_add_u32 s34, s34, 756
    buffer_load_dwordx4 v4, s[16:19], s34 offen lds
    s_add_u32 m0, s35, 63216
    s_add_u32 s34, s34, 756
    buffer_load_dwordx4 v4, s[16:19], s34 offen lds
    s_add_u32 m0, s35, 64224
    s_add_u32 s34, s34, 756
    buffer_load_dwordx4 v4, s[16:19], s34 offen lds
    s_add_u32 m0, s35, 65232
    s_add_u32 s34, s34, 756
    buffer_load_dwordx4 v4, s[16:19], s34 offen lds
    s_add_u32 m0, s35, 66240
    s_add_u32 s34, s34, 756
    buffer_load_dwordx4 v4, s[16:19], s34 offen lds
    s_mov_b32 exec_hi, -1
    s_load_dwordx2 s[64:65], s[28:29], 253952
    s_and_b32 s33, s3, 6
    s_and_b32 s34, s5, 6
    s_and_b32 s35, s3, 1
    s_add_u32 s34, s34, s35
    s_add_u32 s34, s34, s33
    s_and_b32 s34, s34, 7
    s_mul_i32 s62, s34, 9216
    s_mul_i32 s35, s4, 73728
    s_add_u32 s62, s62, s35
    s_lshr_b32 s35, s34, 2
    s_mul_i32 s35, s35, 32768
    s_lshl_b32 s63, s34, 10
    s_add_u32 s63, s63, s35
    s_add_u32 s63, s63, 88704
    s_sub_u32 s33, s3, 2
    s_mul_i32 s60, s33, 6912
    s_mul_i32 s35, s5, 144
    s_add_u32 s60, s60, s35
    s_mul_i32 s94, s33, 912
    s_mov_b32 s92, 0xfffbffff
    s_mov_b32 s93, 0xffffdf
    s_setprio 2
    s_add_u32 m0, s63, 0
    s_nop 0
    buffer_load_dwordx4 v2, s[8:11], s62 offen offset:0 lds
    s_add_u32 m0, s63, 3968
    s_nop 0
    buffer_load_dwordx4 v2, s[8:11], s62 offen offset:128 lds
    s_add_u32 m0, s63, 7936
    s_nop 0
    buffer_load_dwordx4 v2, s[8:11], s62 offen offset:256 lds
    s_mov_b64 exec, s[92:93]
    s_add_u32 m0, s94, 0
    s_add_u32 s60, s60, 0
    buffer_load_dwordx4 v175, s[12:15], s60 offen lds
    s_add_u32 m0, s94, 5472
    s_add_u32 s60, s60, 41472
    buffer_load_dwordx4 v175, s[12:15], s60 offen lds
    s_add_u32 m0, s94, 10944
    s_add_u32 s60, s60, 41472
    buffer_load_dwordx4 v175, s[12:15], s60 offen lds
    s_add_u32 m0, s94, 16416
    s_add_u32 s60, s60, 41472
    buffer_load_dwordx4 v175, s[12:15], s60 offen lds
    s_mov_b64 exec, -1
    s_waitcnt vmcnt(7)
    s_barrier
    s_setprio 1
    s_add_u32 m0, s63, 11904
    s_nop 0
    buffer_load_dwordx4 v2, s[8:11], s62 offen offset:384 lds
    s_add_u32 m0, s63, 15872
    s_nop 0
    buffer_load_dwordx4 v2, s[8:11], s62 offen offset:512 lds
    s_mov_b64 exec, s[92:93]
    s_add_u32 m0, s94, 21888
    s_add_u32 s60, s60, 41472
    buffer_load_dwordx4 v175, s[12:15], s60 offen lds
    s_add_u32 m0, s94, 27360
    s_add_u32 s60, s60, 41472
    buffer_load_dwordx4 v175, s[12:15], s60 offen lds
    s_add_u32 m0, s94, 32832
    s_add_u32 s60, s60, 41472
    buffer_load_dwordx4 v175, s[12:15], s60 offen lds
    s_add_u32 m0, s94, 38304
    s_add_u32 s60, s60, 41472
    buffer_load_dwordx4 v175, s[12:15], s60 offen lds
    s_mov_b64 exec, -1
    s_and_b32 s34, s5, 6
    s_and_b32 s35, s3, 1
    s_add_u32 s34, s34, s35
    s_add_u32 s34, s34, 2
    s_and_b32 s34, s34, 7
    s_mul_i32 s52, s34, 9216
    s_mul_i32 s35, s4, 73728
    s_add_u32 s52, s52, s35
    s_lshr_b32 s35, s34, 2
    s_mul_i32 s35, s35, 32768
    s_lshl_b32 s53, s34, 10
    s_add_u32 s53, s53, s35
    s_add_u32 s53, s53, 88704
    s_lshr_b32 s34, s3, 1
    s_lshl_b32 s35, s34, 7
    s_add_u32 s52, s52, s35
    s_lshl_b32 s35, s34, 12
    s_add_u32 s53, s53, s35
    s_and_b32 s34, s5, 6
    s_and_b32 s35, s3, 1
    s_add_u32 s34, s34, s35
    s_add_u32 s34, s34, 4
    s_and_b32 s34, s34, 7
    s_mul_i32 s54, s34, 9216
    s_mul_i32 s35, s4, 73728
    s_add_u32 s54, s54, s35
    s_lshr_b32 s35, s34, 2
    s_mul_i32 s35, s35, 32768
    s_lshl_b32 s55, s34, 10
    s_add_u32 s55, s55, s35
    s_add_u32 s55, s55, 88704
    s_lshr_b32 s34, s3, 1
    s_lshl_b32 s35, s34, 7
    s_add_u32 s54, s54, s35
    s_lshl_b32 s35, s34, 12
    s_add_u32 s55, s55, s35
    s_and_b32 s34, s5, 6
    s_and_b32 s35, s3, 1
    s_add_u32 s34, s34, s35
    s_add_u32 s34, s34, 6
    s_and_b32 s34, s34, 7
    s_mul_i32 s62, s34, 9216
    s_mul_i32 s35, s4, 73728
    s_add_u32 s62, s62, s35
    s_lshr_b32 s35, s34, 2
    s_mul_i32 s35, s35, 32768
    s_lshl_b32 s63, s34, 10
    s_add_u32 s63, s63, s35
    s_add_u32 s63, s63, 88704
    s_lshr_b32 s34, s3, 1
    s_lshl_b32 s35, s34, 7
    s_add_u32 s62, s62, s35
    s_lshl_b32 s35, s34, 12
    s_add_u32 s63, s63, s35
    s_mul_i32 s60, s3, 6912
    s_mul_i32 s35, s5, 144
    s_add_u32 s60, s60, s35
    s_add_u32 s60, s60, 331776
    s_mul_i32 s94, s3, 912
    s_mov_b32 s92, 0xfffbffff
    s_mov_b32 s93, 0xffffdf
    s_setprio 3
    s_waitcnt vmcnt(6)
    s_barrier
    s_add_u32 m0, s53, 19840
    s_nop 0
    buffer_load_dwordx4 v2, s[8:11], s52 offen offset:640 lds
    s_add_u32 m0, s55, 19840
    s_nop 0
    buffer_load_dwordx4 v2, s[8:11], s54 offen offset:640 lds
    s_add_u32 m0, s63, 19840
    s_nop 0
    buffer_load_dwordx4 v2, s[8:11], s62 offen offset:640 lds
    s_mov_b64 exec, s[92:93]
    s_add_u32 m0, s94, 43776
    s_add_u32 s60, s60, 0
    buffer_load_dwordx4 v175, s[12:15], s60 offen lds
    s_add_u32 m0, s94, 47424
    s_add_u32 s60, s60, 27648
    buffer_load_dwordx4 v175, s[12:15], s60 offen lds
    s_add_u32 m0, s94, 51072
    s_add_u32 s60, s60, 27648
    buffer_load_dwordx4 v175, s[12:15], s60 offen lds
    s_add_u32 m0, s94, 54720
    s_add_u32 s60, s60, 27648
    buffer_load_dwordx4 v175, s[12:15], s60 offen lds
    s_add_u32 m0, s94, 58368
    s_add_u32 s60, s60, 27648
    buffer_load_dwordx4 v175, s[12:15], s60 offen lds
    s_add_u32 m0, s94, 62016
    s_add_u32 s60, s60, 27648
    buffer_load_dwordx4 v175, s[12:15], s60 offen lds
    s_mov_b64 exec, -1
    s_waitcnt vmcnt(9)
    s_barrier
    s_add_u32 m0, s53, 27776
    s_nop 0
    buffer_load_dwordx4 v2, s[8:11], s52 offen offset:896 lds
    s_add_u32 m0, s55, 27776
    s_nop 0
    buffer_load_dwordx4 v2, s[8:11], s54 offen offset:896 lds
    s_add_u32 m0, s63, 27776
    s_nop 0
    buffer_load_dwordx4 v2, s[8:11], s62 offen offset:896 lds
    s_mov_b64 exec, s[92:93]
    s_add_u32 m0, s94, 65664
    s_add_u32 s60, s60, 27648
    buffer_load_dwordx4 v175, s[12:15], s60 offen lds
    s_add_u32 m0, s94, 69312
    s_add_u32 s60, s60, 27648
    buffer_load_dwordx4 v175, s[12:15], s60 offen lds
    s_add_u32 m0, s94, 72960
    s_add_u32 s60, s60, 27648
    buffer_load_dwordx4 v175, s[12:15], s60 offen lds
    s_add_u32 m0, s94, 76608
    s_add_u32 s60, s60, 27648
    buffer_load_dwordx4 v175, s[12:15], s60 offen lds
    s_add_u32 m0, s94, 80256
    s_add_u32 s60, s60, 27648
    buffer_load_dwordx4 v175, s[12:15], s60 offen lds
    s_add_u32 m0, s94, 83904
    s_add_u32 s60, s60, 27648
    buffer_load_dwordx4 v175, s[12:15], s60 offen lds
    s_mov_b64 exec, -1
    s_waitcnt vmcnt(9)
    s_barrier
    v_mov_b32 v137, 0
    v_mov_b32 v138, 0
    v_and_b32 v12, 31, v1
    v_lshrrev_b32 v14, 5, v1
    v_mul_u32_u24 v14, 304, v14
    v_lshl_add_u32 v14, v12, 4, v14
    v_cmp_lt_u32 vcc, 18, v12
    s_mul_i32 s34, s7, 4864
    s_add_u32 s34, s34, 9216
    v_add_u32 v165, s34, v14
    v_mov_b32 v13, 0x40000
    v_cndmask_b32 v165, v165, v13, vcc
    s_lshl_b32 s34, s7, 12
    v_add_u32 v164, s34, v5
    s_lshl_b32 s34, s7, 3
    s_add_u32 s34, s34, 8192
    v_add_u32 v166, s34, v5
    v_mul_u32_u24 v12, 57, v1
    v_lshrrev_b32 v12, 9, v12
    v_mul_u32_u24 v12, 1008, v12
    v_add_u32 v3, v12, v5
    s_lshr_b32 s34, s4, 2
    s_add_u32 s34, s34, s3
    s_add_u32 s34, s34, 1
    s_and_b32 s34, s34, 7
    s_mul_i32 s58, s34, 19456
    s_lshl_b32 s34, s34, 10
    s_add_u32 s57, s34, 196608
    s_mul_i32 s59, s3, 19456
    s_lshl_b32 s34, s3, 10
    s_add_u32 s34, s34, 155648
    v_add_u32 v84, s34, v5
    s_lshr_b32 s34, s6, 1
    s_mul_i32 s34, s34, 18944
    s_lshl_b32 s35, s6, 8
    s_add_u32 s34, s34, s35
    s_add_u32 s34, s34, 18944
    v_lshl_add_u32 v86, v1, 2, s34
    s_lshl_b32 s35, s7, 7
    v_add_u32 v85, s35, v86
    v_xor_b32 v86, s35, v86
    s_xor_b32 s34, s3, 4
    s_lshl_b32 s34, s34, 10
    s_add_u32 s34, s34, 155648
    v_add_u32 v87, s34, v5
    s_waitcnt lgkmcnt(0)
    s_add_u32 s64, s64, 0x7f4a7c15
    s_addc_u32 s65, s65, 0x9e3779b9
    v_mov_b32 v172, s64
    v_mov_b32 v173, s65
    s_waitcnt vmcnt(0)
    s_barrier
    v_and_b32 v180, 31, v1
    v_lshlrev_b32 v180, 5, v180
    buffer_load_dwordx4 v[176:179], v180, s[28:31], s57 offen sc1
    s_setprio 0
    s_barrier
    s_branch L_qb
L_roleC:
    v_mul_u32_u24 v12, 171, v1
    v_lshrrev_b32 v12, 9, v12
    v_mul_u32_u24 v12, 12, v12
    v_sub_u32 v4, v5, v12
    s_mov_b32 s18, 20736
    s_mov_b32 s19, 0x20000
    s_and_b32 s6, s3, 3
    s_lshr_b32 s7, s3, 2
    v_mul_u32_u24 v12, 27, v1
    v_lshrrev_b32 v12, 9, v12
    v_mul_u32_u24 v13, 19, v12
    v_sub_u32 v13, v1, v13
    v_mul_u32_u24 v12, 2304, v12
    v_lshl_add_u32 v12, v13, 4, v12
    v_cmp_le_u32 vcc, 9, v13
    v_add_u32 v13, 1008, v12
    s_mov_b32 s14, 663552
    v_cndmask_b32 v175, v12, v13, vcc
    s_mov_b32 s15, 0x20000
    s_mov_b32 s30, 2621440
    s_mov_b32 s31, 0x20000
    s_mov_b32 s22, 663552
    s_mov_b32 s23, 0x20000
    s_mov_b32 s26, 2359296
    s_mov_b32 s27, 0x20000
    s_bitcmp1_b32 s5, 0
    s_waitcnt lgkmcnt(0)
    s_cselect_b32 s16, s42, s40
    s_cselect_b32 s17, s43, s41
    s_load_dwordx2 s[64:65], s[28:29], 253952
    s_cmp_ge_u32 s3, 6
    s_cbranch_scc1 L_nowkv
    s_sub_u32 s33, s3, 2
    s_mul_i32 s34, s33, 5292
    s_mul_i32 s35, s33, 7056
    s_mov_b32 exec_hi, 0x7fffffff
    s_add_u32 m0, s35, 60192
    s_add_u32 s34, s34, 0
    buffer_load_dwordx4 v4, s[16:19], s34 offen lds
    s_add_u32 m0, s35, 61200
    s_add_u32 s34, s34, 756
    buffer_load_dwordx4 v4, s[16:19], s34 offen lds
    s_add_u32 m0, s35, 62208
    s_add_u32 s34, s34, 756
    buffer_load_dwordx4 v4, s[16:19], s34 offen lds
    s_add_u32 m0, s35, 63216
    s_add_u32 s34, s34, 756
    buffer_load_dwordx4 v4, s[16:19], s34 offen lds
    s_add_u32 m0, s35, 64224
    s_add_u32 s34, s34, 756
    buffer_load_dwordx4 v4, s[16:19], s34 offen lds
    s_add_u32 m0, s35, 65232
    s_add_u32 s34, s34, 756
    buffer_load_dwordx4 v4, s[16:19], s34 offen lds
    s_add_u32 m0, s35, 66240
    s_add_u32 s34, s34, 756
    buffer_load_dwordx4 v4, s[16:19], s34 offen lds
    s_mov_b32 exec_hi, -1
L_nowkv:
    s_cmp_lt_u32 s3, 6
    s_cbranch_scc1 L_touched
    s_lshr_b32 s33, s2, 3
    v_lshlrev_b32 v12, 7, v1
    s_cmp_eq_u32 s3, 7
    s_cbranch_scc1 L_t7
    s_mul_i32 s34, s33, 8192
    s_add_u32 s34, s34, 0
    buffer_load_dword v254, v12, s[12:15], s34 offen
    s_mul_i32 s34, s33, 8192
    s_add_u32 s34, s34, 262144
    buffer_load_dword v254, v12, s[12:15], s34 offen
    s_branch L_touched
L_t7:
    s_cmp_ge_u32 s33, 8
    s_cbranch_scc1 L_noct
    s_getpc_b64 s[34:35]
L_pc:
    s_and_b32 s32, s33, 3
    s_lshl_b32 s32, s32, 13
    v_add_u32 v13, s32, v12
    v_min_u32 v13, CODE_END - L_pc - 64, v13
    global_load_dword v254, v13, s[34:35]
L_noct:
    s_mul_i32 s34, s33, 4352
    s_add_u32 s34, s34, 524288
    s_mov_b32 exec_hi, 3
    buffer_load_dword v254, v12, s[12:15], s34 offen
    s_mov_b32 exec_hi, -1
L_touched:
    s_and_b32 s33, s3, 6
    s_and_b32 s34, s5, 6
    s_and_b32 s35, s3, 1
    s_add_u32 s34, s34, s35
    s_add_u32 s34, s34, s33
    s_and_b32 s34, s34, 7
    s_mul_i32 s62, s34, 9216
    s_mul_i32 s35, s4, 73728
    s_add_u32 s62, s62, s35
    s_lshr_b32 s35, s34, 2
    s_mul_i32 s35, s35, 32768
    s_lshl_b32 s63, s34, 10
    s_add_u32 s63, s63, s35
    s_add_u32 s63, s63, 88704
    s_sub_u32 s33, s3, 2
    s_mul_i32 s60, s33, 6912
    s_mul_i32 s35, s5, 144
    s_add_u32 s60, s60, s35
    s_mul_i32 s94, s33, 912
    s_mov_b32 s92, 0xfffbffff
    s_mov_b32 s93, 0xffffdf
    s_setprio 2
    s_add_u32 m0, s63, 0
    s_nop 0
    buffer_load_dwordx4 v2, s[8:11], s62 offen offset:0 lds
    s_add_u32 m0, s63, 3968
    s_nop 0
    buffer_load_dwordx4 v2, s[8:11], s62 offen offset:128 lds
    s_add_u32 m0, s63, 7936
    s_nop 0
    buffer_load_dwordx4 v2, s[8:11], s62 offen offset:256 lds
    s_mov_b64 exec, s[92:93]
    s_add_u32 m0, s94, 0
    s_add_u32 s60, s60, 0
    buffer_load_dwordx4 v175, s[12:15], s60 offen lds
    s_add_u32 m0, s94, 5472
    s_add_u32 s60, s60, 41472
    buffer_load_dwordx4 v175, s[12:15], s60 offen lds
    s_add_u32 m0, s94, 10944
    s_add_u32 s60, s60, 41472
    buffer_load_dwordx4 v175, s[12:15], s60 offen lds
    s_add_u32 m0, s94, 16416
    s_add_u32 s60, s60, 41472
    buffer_load_dwordx4 v175, s[12:15], s60 offen lds
    s_mov_b64 exec, -1
    s_cmp_ge_u32 s3, 6
    s_cbranch_scc1 L_b1
    s_waitcnt vmcnt(7)
L_b1:
    s_barrier
    s_setprio 1
    s_add_u32 m0, s63, 11904
    s_nop 0
    buffer_load_dwordx4 v2, s[8:11], s62 offen offset:384 lds
    s_add_u32 m0, s63, 15872
    s_nop 0
    buffer_load_dwordx4 v2, s[8:11], s62 offen offset:512 lds
    s_mov_b64 exec, s[92:93]
    s_add_u32 m0, s94, 21888
    s_add_u32 s60, s60, 41472
    buffer_load_dwordx4 v175, s[12:15], s60 offen lds
    s_add_u32 m0, s94, 27360
    s_add_u32 s60, s60, 41472
    buffer_load_dwordx4 v175, s[12:15], s60 offen lds
    s_add_u32 m0, s94, 32832
    s_add_u32 s60, s60, 41472
    buffer_load_dwordx4 v175, s[12:15], s60 offen lds
    s_add_u32 m0, s94, 38304
    s_add_u32 s60, s60, 41472
    buffer_load_dwordx4 v175, s[12:15], s60 offen lds
    s_mov_b64 exec, -1
    s_setprio 0
    s_mov_b32 s34, 88704
    v_and_b32 v12, 31, v1
    v_lshrrev_b32 v13, 1, v12
    v_lshrrev_b32 v14, 5, v1
    v_xor_b32 v13, v13, v14
    v_and_b32 v13, 7, v13
    v_lshlrev_b32 v13, 4, v13
    v_lshl_add_u32 v13, v12, 7, v13
    v_add_u32 v6, s34, v13
    v_xor_b32 v7, 32, v6
    v_xor_b32 v8, 64, v6
    v_xor_b32 v9, 0x60, v6
    s_and_b32 s35, s6, 1
    s_mul_i32 s34, s6, 18
    s_sub_u32 s34, s34, s35
    s_sub_u32 s34, s34, s35
    s_lshl_b32 s34, s34, 1
    s_add_u32 s34, s34, 0
    s_add_u32 s35, s35, 2
    v_bfe_u32 v12, v1, 4, 1
    v_bfe_u32 v13, v1, 1, 1
    v_lshl_add_u32 v12, v12, 1, v13
    v_and_b32 v13, 1, v1
    v_lshlrev_b32 v13, 4, v13
    v_lshl_add_u32 v13, v12, 3, v13
    v_cmp_le_u32 vcc, s35, v12
    v_bfe_u32 v14, v1, 2, 2
    v_lshrrev_b32 v15, 5, v1
    v_cndmask_b32 v13, v13, 32, vcc
    v_lshrrev_b32 v12, 1, v14
    v_lshl_add_u32 v12, v15, 2, v12
    v_mul_u32_u24 v12, 304, v12
    v_and_b32 v14, 1, v14
    v_mul_u32_u24 v14, 144, v14
    v_add_u32 v14, v14, v12
    v_add3_u32 v10, v13, v14, s34
    v_add_u32 v11, 43776, v10
    v_mov_b32 v137, 0
    v_mov_b32 v138, 0
    v_and_b32 v12, 31, v1
    v_lshrrev_b32 v14, 5, v1
    v_mul_u32_u24 v14, 304, v14
    v_lshl_add_u32 v14, v12, 4, v14
    v_cmp_lt_u32 vcc, 18, v12
    s_mul_i32 s34, s7, 4864
    s_add_u32 s34, s34, 9216
    v_add_u32 v165, s34, v14
    v_mov_b32 v13, 0x40000
    v_cndmask_b32 v165, v165, v13, vcc
    s_lshl_b32 s34, s7, 12
    v_add_u32 v164, s34, v5
    s_lshl_b32 s34, s7, 3
    s_add_u32 s34, s34, 8192
    v_add_u32 v166, s34, v5
    v_mul_u32_u24 v12, 57, v1
    v_lshrrev_b32 v12, 9, v12
    v_mul_u32_u24 v12, 1008, v12
    v_add_u32 v3, v12, v5
    s_lshr_b32 s34, s4, 2
    s_add_u32 s34, s34, s3
    s_add_u32 s34, s34, 1
    s_and_b32 s34, s34, 7
    s_mul_i32 s58, s34, 19456
    s_lshl_b32 s34, s34, 10
    s_add_u32 s57, s34, 196608
    s_mul_i32 s59, s3, 19456
    s_lshl_b32 s34, s3, 10
    s_add_u32 s34, s34, 155648
    v_add_u32 v84, s34, v5
    s_lshr_b32 s34, s6, 1
    s_mul_i32 s34, s34, 18944
    s_lshl_b32 s35, s6, 8
    s_add_u32 s34, s34, s35
    s_add_u32 s34, s34, 18944
    v_lshl_add_u32 v86, v1, 2, s34
    s_lshl_b32 s35, s7, 7
    v_add_u32 v85, s35, v86
    v_xor_b32 v86, s35, v86
    s_xor_b32 s34, s3, 4
    s_lshl_b32 s34, s34, 10
    s_add_u32 s34, s34, 155648
    v_add_u32 v87, s34, v5
    v_add_u32 v88, 0x8000, v6
    v_add_u32 v89, 0x8000, v7
    v_add_u32 v90, 0x8000, v8
    v_add_u32 v91, 0x8000, v9
    s_waitcnt vmcnt(6) lgkmcnt(0)
    s_waitcnt lgkmcnt(0)
    s_add_u32 s64, s64, 0x7f4a7c15
    s_addc_u32 s65, s65, 0x9e3779b9
    v_mov_b32 v172, s64
    v_mov_b32 v173, s65
    s_barrier
    ds_read_b64_tr_b16 v[48:49], v10 offset:0
    ds_read_b64_tr_b16 v[50:51], v10 offset:608
    ds_read_b128 v[52:55], v6 offset:0
    ds_read_b128 v[56:59], v6 offset:36864
    ds_read_b64_tr_b16 v[60:61], v10 offset:2432
    ds_read_b64_tr_b16 v[62:63], v10 offset:3040
    ds_read_b128 v[64:67], v7 offset:0
    ds_read_b128 v[68:71], v7 offset:36864
    ds_read_b64_tr_b16 v[72:73], v10 offset:4864
    ds_read_b64_tr_b16 v[74:75], v10 offset:5472
    ds_read_b128 v[76:79], v8 offset:0
    ds_read_b128 v[80:83], v8 offset:36864
    s_waitcnt lgkmcnt(8)
    v_mfma_f32_32x32x16_bf16 v[16:31], v[48:51], v[52:55], 0
    v_mfma_f32_32x32x16_bf16 v[32:47], v[48:51], v[56:59], 0
    ds_read_b64_tr_b16 v[48:49], v10 offset:7296
    ds_read_b64_tr_b16 v[50:51], v10 offset:7904
    ds_read_b128 v[52:55], v9 offset:0
    ds_read_b128 v[56:59], v9 offset:36864
    s_waitcnt lgkmcnt(8)
    v_mfma_f32_32x32x16_bf16 v[16:31], v[60:63], v[64:67], v[16:31]
    v_mfma_f32_32x32x16_bf16 v[32:47], v[60:63], v[68:71], v[32:47]
    ds_read_b64_tr_b16 v[60:61], v10 offset:9728
    ds_read_b64_tr_b16 v[62:63], v10 offset:10336
    ds_read_b128 v[64:67], v6 offset:4096
    ds_read_b128 v[68:71], v6 offset:40960
    s_waitcnt lgkmcnt(8)
    v_mfma_f32_32x32x16_bf16 v[16:31], v[72:75], v[76:79], v[16:31]
    v_mfma_f32_32x32x16_bf16 v[32:47], v[72:75], v[80:83], v[32:47]
    ds_read_b64_tr_b16 v[72:73], v10 offset:12160
    ds_read_b64_tr_b16 v[74:75], v10 offset:12768
    ds_read_b128 v[76:79], v7 offset:4096
    ds_read_b128 v[80:83], v7 offset:40960
    s_waitcnt lgkmcnt(8)
    v_mfma_f32_32x32x16_bf16 v[16:31], v[48:51], v[52:55], v[16:31]
    v_mfma_f32_32x32x16_bf16 v[32:47], v[48:51], v[56:59], v[32:47]
    ds_read_b64_tr_b16 v[48:49], v10 offset:14592
    ds_read_b64_tr_b16 v[50:51], v10 offset:15200
    ds_read_b128 v[52:55], v8 offset:4096
    ds_read_b128 v[56:59], v8 offset:40960
    s_waitcnt lgkmcnt(8)
    v_mfma_f32_32x32x16_bf16 v[16:31], v[60:63], v[64:67], v[16:31]
    v_mfma_f32_32x32x16_bf16 v[32:47], v[60:63], v[68:71], v[32:47]
    ds_read_b64_tr_b16 v[60:61], v10 offset:17024
    ds_read_b64_tr_b16 v[62:63], v10 offset:17632
    ds_read_b128 v[64:67], v9 offset:4096
    ds_read_b128 v[68:71], v9 offset:40960
    s_waitcnt lgkmcnt(8)
    v_mfma_f32_32x32x16_bf16 v[16:31], v[72:75], v[76:79], v[16:31]
    v_mfma_f32_32x32x16_bf16 v[32:47], v[72:75], v[80:83], v[32:47]
    ds_read_b64_tr_b16 v[72:73], v10 offset:19456
    ds_read_b64_tr_b16 v[74:75], v10 offset:20064
    ds_read_b128 v[76:79], v6 offset:8192
    ds_read_b128 v[80:83], v6 offset:45056
    s_waitcnt lgkmcnt(8)
    v_mfma_f32_32x32x16_bf16 v[16:31], v[48:51], v[52:55], v[16:31]
    v_mfma_f32_32x32x16_bf16 v[32:47], v[48:51], v[56:59], v[32:47]
    s_waitcnt vmcnt(0)
    s_barrier
    ds_read_b64_tr_b16 v[48:49], v10 offset:21888
    ds_read_b64_tr_b16 v[50:51], v10 offset:22496
    ds_read_b128 v[52:55], v7 offset:8192
    ds_read_b128 v[56:59], v7 offset:45056
    s_waitcnt lgkmcnt(8)
    v_mfma_f32_32x32x16_bf16 v[16:31], v[60:63], v[64:67], v[16:31]
    v_mfma_f32_32x32x16_bf16 v[32:47], v[60:63], v[68:71], v[32:47]
    ds_read_b64_tr_b16 v[60:61], v10 offset:24320
    ds_read_b64_tr_b16 v[62:63], v10 offset:24928
    ds_read_b128 v[64:67], v8 offset:8192
    ds_read_b128 v[68:71], v8 offset:45056
    s_waitcnt lgkmcnt(8)
    v_mfma_f32_32x32x16_bf16 v[16:31], v[72:75], v[76:79], v[16:31]
    v_mfma_f32_32x32x16_bf16 v[32:47], v[72:75], v[80:83], v[32:47]
    ds_read_b64_tr_b16 v[72:73], v10 offset:26752
    ds_read_b64_tr_b16 v[74:75], v10 offset:27360
    ds_read_b128 v[76:79], v9 offset:8192
    ds_read_b128 v[80:83], v9 offset:45056
    s_waitcnt lgkmcnt(8)
    v_mfma_f32_32x32x16_bf16 v[16:31], v[48:51], v[52:55], v[16:31]
    v_mfma_f32_32x32x16_bf16 v[32:47], v[48:51], v[56:59], v[32:47]
    ds_read_b64_tr_b16 v[48:49], v10 offset:29184
    ds_read_b64_tr_b16 v[50:51], v10 offset:29792
    ds_read_b128 v[52:55], v6 offset:12288
    ds_read_b128 v[56:59], v6 offset:49152
    s_waitcnt lgkmcnt(8)
    v_mfma_f32_32x32x16_bf16 v[16:31], v[60:63], v[64:67], v[16:31]
    v_mfma_f32_32x32x16_bf16 v[32:47], v[60:63], v[68:71], v[32:47]
    ds_read_b64_tr_b16 v[60:61], v10 offset:31616
    ds_read_b64_tr_b16 v[62:63], v10 offset:32224
    ds_read_b128 v[64:67], v7 offset:12288
    ds_read_b128 v[68:71], v7 offset:49152
    s_waitcnt lgkmcnt(8)
    v_mfma_f32_32x32x16_bf16 v[16:31], v[72:75], v[76:79], v[16:31]
    v_mfma_f32_32x32x16_bf16 v[32:47], v[72:75], v[80:83], v[32:47]
    ds_read_b64_tr_b16 v[72:73], v10 offset:34048
    ds_read_b64_tr_b16 v[74:75], v10 offset:34656
    ds_read_b128 v[76:79], v8 offset:12288
    ds_read_b128 v[80:83], v8 offset:49152
    s_waitcnt lgkmcnt(8)
    v_mfma_f32_32x32x16_bf16 v[16:31], v[48:51], v[52:55], v[16:31]
    v_mfma_f32_32x32x16_bf16 v[32:47], v[48:51], v[56:59], v[32:47]
    ds_read_b64_tr_b16 v[48:49], v10 offset:36480
    ds_read_b64_tr_b16 v[50:51], v10 offset:37088
    ds_read_b128 v[52:55], v9 offset:12288
    ds_read_b128 v[56:59], v9 offset:49152
    s_waitcnt lgkmcnt(8)
    v_mfma_f32_32x32x16_bf16 v[16:31], v[60:63], v[64:67], v[16:31]
    v_mfma_f32_32x32x16_bf16 v[32:47], v[60:63], v[68:71], v[32:47]
    ds_read_b64_tr_b16 v[60:61], v10 offset:38912
    ds_read_b64_tr_b16 v[62:63], v10 offset:39520
    ds_read_b128 v[64:67], v6 offset:16384
    ds_read_b128 v[68:71], v6 offset:53248
    s_waitcnt lgkmcnt(8)
    v_mfma_f32_32x32x16_bf16 v[16:31], v[72:75], v[76:79], v[16:31]
    v_mfma_f32_32x32x16_bf16 v[32:47], v[72:75], v[80:83], v[32:47]
    ds_read_b64_tr_b16 v[72:73], v10 offset:41344
    ds_read_b64_tr_b16 v[74:75], v10 offset:41952
    ds_read_b128 v[76:79], v7 offset:16384
    ds_read_b128 v[80:83], v7 offset:53248
    s_waitcnt lgkmcnt(8)
    v_mfma_f32_32x32x16_bf16 v[16:31], v[48:51], v[52:55], v[16:31]
    v_mfma_f32_32x32x16_bf16 v[32:47], v[48:51], v[56:59], v[32:47]
    s_barrier
    ds_read_b64_tr_b16 v[48:49], v11 offset:0
    ds_read_b64_tr_b16 v[50:51], v11 offset:608
    ds_read_b128 v[52:55], v8 offset:16384
    ds_read_b128 v[56:59], v8 offset:53248
    s_waitcnt lgkmcnt(8)
    v_mfma_f32_32x32x16_bf16 v[16:31], v[60:63], v[64:67], v[16:31]
    v_mfma_f32_32x32x16_bf16 v[32:47], v[60:63], v[68:71], v[32:47]
    ds_read_b64_tr_b16 v[60:61], v11 offset:2432
    ds_read_b64_tr_b16 v[62:63], v11 offset:3040
    ds_read_b128 v[64:67], v9 offset:16384
    ds_read_b128 v[68:71], v9 offset:53248
    s_waitcnt lgkmcnt(8)
    v_mfma_f32_32x32x16_bf16 v[16:31], v[72:75], v[76:79], v[16:31]
    v_mfma_f32_32x32x16_bf16 v[32:47], v[72:75], v[80:83], v[32:47]
    ds_read_b64_tr_b16 v[72:73], v11 offset:4864
    ds_read_b64_tr_b16 v[74:75], v11 offset:5472
    ds_read_b128 v[76:79], v6 offset:20480
    ds_read_b128 v[80:83], v6 offset:57344
    s_waitcnt lgkmcnt(8)
    v_mfma_f32_32x32x16_bf16 v[16:31], v[48:51], v[52:55], v[16:31]
    v_mfma_f32_32x32x16_bf16 v[32:47], v[48:51], v[56:59], v[32:47]
    ds_read_b64_tr_b16 v[48:49], v11 offset:7296
    ds_read_b64_tr_b16 v[50:51], v11 offset:7904
    ds_read_b128 v[52:55], v7 offset:20480
    ds_read_b128 v[56:59], v7 offset:57344
    s_waitcnt lgkmcnt(8)
    v_mfma_f32_32x32x16_bf16 v[16:31], v[60:63], v[64:67], v[16:31]
    v_mfma_f32_32x32x16_bf16 v[32:47], v[60:63], v[68:71], v[32:47]
    ds_read_b64_tr_b16 v[60:61], v11 offset:9728
    ds_read_b64_tr_b16 v[62:63], v11 offset:10336
    ds_read_b128 v[64:67], v8 offset:20480
    ds_read_b128 v[68:71], v8 offset:57344
    s_waitcnt lgkmcnt(8)
    v_mfma_f32_32x32x16_bf16 v[16:31], v[72:75], v[76:79], v[16:31]
    v_mfma_f32_32x32x16_bf16 v[32:47], v[72:75], v[80:83], v[32:47]
    ds_read_b64_tr_b16 v[72:73], v11 offset:12160
    ds_read_b64_tr_b16 v[74:75], v11 offset:12768
    ds_read_b128 v[76:79], v9 offset:20480
    ds_read_b128 v[80:83], v9 offset:57344
    s_waitcnt lgkmcnt(8)
    v_mfma_f32_32x32x16_bf16 v[16:31], v[48:51], v[52:55], v[16:31]
    v_mfma_f32_32x32x16_bf16 v[32:47], v[48:51], v[56:59], v[32:47]
    ds_read_b64_tr_b16 v[48:49], v11 offset:14592
    ds_read_b64_tr_b16 v[50:51], v11 offset:15200
    ds_read_b128 v[52:55], v6 offset:24576
    ds_read_b128 v[56:59], v6 offset:61440
    s_waitcnt lgkmcnt(8)
    v_mfma_f32_32x32x16_bf16 v[16:31], v[60:63], v[64:67], v[16:31]
    v_mfma_f32_32x32x16_bf16 v[32:47], v[60:63], v[68:71], v[32:47]
    ds_read_b64_tr_b16 v[60:61], v11 offset:17024
    ds_read_b64_tr_b16 v[62:63], v11 offset:17632
    ds_read_b128 v[64:67], v7 offset:24576
    ds_read_b128 v[68:71], v7 offset:61440
    s_waitcnt lgkmcnt(8)
    v_mfma_f32_32x32x16_bf16 v[16:31], v[72:75], v[76:79], v[16:31]
    v_mfma_f32_32x32x16_bf16 v[32:47], v[72:75], v[80:83], v[32:47]
    ds_read_b64_tr_b16 v[72:73], v11 offset:19456
    ds_read_b64_tr_b16 v[74:75], v11 offset:20064
    ds_read_b128 v[76:79], v8 offset:24576
    ds_read_b128 v[80:83], v8 offset:61440
    s_waitcnt lgkmcnt(8)
    v_mfma_f32_32x32x16_bf16 v[16:31], v[48:51], v[52:55], v[16:31]
    v_mfma_f32_32x32x16_bf16 v[32:47], v[48:51], v[56:59], v[32:47]
    s_barrier
    v_and_b32 v180, 31, v1
    v_lshlrev_b32 v180, 5, v180
    buffer_load_dwordx4 v[176:179], v180, s[28:31], s57 offen sc1
    ds_read_b64_tr_b16 v[48:49], v11 offset:21888
    ds_read_b64_tr_b16 v[50:51], v11 offset:22496
    ds_read_b128 v[52:55], v9 offset:24576
    ds_read_b128 v[56:59], v9 offset:61440
    s_waitcnt lgkmcnt(8)
    v_mfma_f32_32x32x16_bf16 v[16:31], v[60:63], v[64:67], v[16:31]
    v_mfma_f32_32x32x16_bf16 v[32:47], v[60:63], v[68:71], v[32:47]
    ds_read_b64_tr_b16 v[60:61], v11 offset:24320
    ds_read_b64_tr_b16 v[62:63], v11 offset:24928
    ds_read_b128 v[64:67], v6 offset:28672
    ds_read_b128 v[68:71], v88 offset:32768
    s_waitcnt lgkmcnt(8)
    v_mfma_f32_32x32x16_bf16 v[16:31], v[72:75], v[76:79], v[16:31]
    v_mfma_f32_32x32x16_bf16 v[32:47], v[72:75], v[80:83], v[32:47]
    ds_read_b64_tr_b16 v[72:73], v11 offset:26752
    ds_read_b64_tr_b16 v[74:75], v11 offset:27360
    ds_read_b128 v[76:79], v7 offset:28672
    ds_read_b128 v[80:83], v89 offset:32768
    s_waitcnt lgkmcnt(8)
    v_mfma_f32_32x32x16_bf16 v[16:31], v[48:51], v[52:55], v[16:31]
    v_mfma_f32_32x32x16_bf16 v[32:47], v[48:51], v[56:59], v[32:47]
    ds_read_b64_tr_b16 v[48:49], v11 offset:29184
    ds_read_b64_tr_b16 v[50:51], v11 offset:29792
    ds_read_b128 v[52:55], v8 offset:28672
    ds_read_b128 v[56:59], v90 offset:32768
    s_waitcnt lgkmcnt(8)
    v_mfma_f32_32x32x16_bf16 v[16:31], v[60:63], v[64:67], v[16:31]
    v_mfma_f32_32x32x16_bf16 v[32:47], v[60:63], v[68:71], v[32:47]
    ds_read_b64_tr_b16 v[60:61], v11 offset:31616
    ds_read_b64_tr_b16 v[62:63], v11 offset:32224
    ds_read_b128 v[64:67], v9 offset:28672
    ds_read_b128 v[68:71], v91 offset:32768
    s_waitcnt lgkmcnt(8)
    v_mfma_f32_32x32x16_bf16 v[16:31], v[72:75], v[76:79], v[16:31]
    v_mfma_f32_32x32x16_bf16 v[32:47], v[72:75], v[80:83], v[32:47]
    ds_read_b64_tr_b16 v[72:73], v11 offset:34048
    ds_read_b64_tr_b16 v[74:75], v11 offset:34656
    ds_read_b128 v[76:79], v6 offset:32768
    ds_read_b128 v[80:83], v88 offset:36864
    s_waitcnt lgkmcnt(8)
    v_mfma_f32_32x32x16_bf16 v[16:31], v[48:51], v[52:55], v[16:31]
    v_mfma_f32_32x32x16_bf16 v[32:47], v[48:51], v[56:59], v[32:47]
    ds_read_b64_tr_b16 v[48:49], v11 offset:36480
    ds_read_b64_tr_b16 v[50:51], v11 offset:37088
    ds_read_b128 v[52:55], v7 offset:32768
    ds_read_b128 v[56:59], v89 offset:36864
    s_waitcnt lgkmcnt(8)
    v_mfma_f32_32x32x16_bf16 v[16:31], v[60:63], v[64:67], v[16:31]
    v_mfma_f32_32x32x16_bf16 v[32:47], v[60:63], v[68:71], v[32:47]
    ds_read_b64_tr_b16 v[60:61], v11 offset:38912
    ds_read_b64_tr_b16 v[62:63], v11 offset:39520
    ds_read_b128 v[64:67], v8 offset:32768
    ds_read_b128 v[68:71], v90 offset:36864
    s_waitcnt lgkmcnt(8)
    v_mfma_f32_32x32x16_bf16 v[16:31], v[72:75], v[76:79], v[16:31]
    v_mfma_f32_32x32x16_bf16 v[32:47], v[72:75], v[80:83], v[32:47]
    ds_read_b64_tr_b16 v[72:73], v11 offset:41344
    ds_read_b64_tr_b16 v[74:75], v11 offset:41952
    ds_read_b128 v[76:79], v9 offset:32768
    ds_read_b128 v[80:83], v91 offset:36864
    s_waitcnt lgkmcnt(8)
    v_mfma_f32_32x32x16_bf16 v[16:31], v[48:51], v[52:55], v[16:31]
    v_mfma_f32_32x32x16_bf16 v[32:47], v[48:51], v[56:59], v[32:47]
    s_waitcnt lgkmcnt(4)
    v_mfma_f32_32x32x16_bf16 v[16:31], v[60:63], v[64:67], v[16:31]
    v_mfma_f32_32x32x16_bf16 v[32:47], v[60:63], v[68:71], v[32:47]
    s_waitcnt lgkmcnt(0)
    v_mfma_f32_32x32x16_bf16 v[16:31], v[72:75], v[76:79], v[16:31]
    v_mfma_f32_32x32x16_bf16 v[32:47], v[72:75], v[80:83], v[32:47]
    s_mov_b32 s34, 0x3eae1a93
    s_nop 7
    s_bitcmp1_b32 s6, 0
    s_cbranch_scc1 L_qodd
    v_mul_f32 v16, s34, v16
    v_mul_f32 v17, s34, v17
    v_mul_f32 v18, s34, v18
    v_mul_f32 v19, s34, v19
    v_mul_f32 v20, s34, v20
    v_mul_f32 v21, s34, v21
    v_mul_f32 v22, s34, v22
    v_mul_f32 v23, s34, v23
    v_mul_f32 v24, s34, v24
    v_mul_f32 v25, s34, v25
    v_cvt_pk_bf16_f32 v48, v16, v17
    v_cvt_pk_bf16_f32 v49, v18, v19
    v_cvt_pk_bf16_f32 v50, v20, v21
    v_cvt_pk_bf16_f32 v51, v22, v23
    v_cvt_pk_bf16_f32 v52, v24, v25
    v_mul_f32 v32, s34, v32
    v_mul_f32 v33, s34, v33
    v_mul_f32 v34, s34, v34
    v_mul_f32 v35, s34, v35
    v_mul_f32 v36, s34, v36
    v_mul_f32 v37, s34, v37
    v_mul_f32 v38, s34, v38
    v_mul_f32 v39, s34, v39
    v_mul_f32 v40, s34, v40
    v_mul_f32 v41, s34, v41
    v_cvt_pk_bf16_f32 v56, v32, v33
    v_cvt_pk_bf16_f32 v57, v34, v35
    v_cvt_pk_bf16_f32 v58, v36, v37
    v_cvt_pk_bf16_f32 v59, v38, v39
    v_cvt_pk_bf16_f32 v60, v40, v41
    s_branch L_qjoin
L_qodd:
    v_mul_f32 v18, s34, v18
    v_mul_f32 v19, s34, v19
    v_mul_f32 v20, s34, v20
    v_mul_f32 v21, s34, v21
    v_mul_f32 v22, s34, v22
    v_mul_f32 v23, s34, v23
    v_mul_f32 v24, s34, v24
    v_mul_f32 v25, s34, v25
    v_mul_f32 v30, s34, v30
    v_mul_f32 v31, s34, v31
    v_cvt_pk_bf16_f32 v48, v18, v19
    v_cvt_pk_bf16_f32 v49, v20, v21
    v_cvt_pk_bf16_f32 v50, v22, v23
    v_cvt_pk_bf16_f32 v51, v24, v25
    v_cvt_pk_bf16_f32 v52, v30, v31
    v_mul_f32 v34, s34, v34
    v_mul_f32 v35, s34, v35
    v_mul_f32 v36, s34, v36
    v_mul_f32 v37, s34, v37
    v_mul_f32 v38, s34, v38
    v_mul_f32 v39, s34, v39
    v_mul_f32 v40, s34, v40
    v_mul_f32 v41, s34, v41
    v_mul_f32 v46, s34, v46
    v_mul_f32 v47, s34, v47
    v_cvt_pk_bf16_f32 v56, v34, v35
    v_cvt_pk_bf16_f32 v57, v36, v37
    v_cvt_pk_bf16_f32 v58, v38, v39
    v_cvt_pk_bf16_f32 v59, v40, v41
    v_cvt_pk_bf16_f32 v60, v46, v47
L_qjoin:
    s_mov_b32 exec_lo, 0
    v_mov_b32 v52, v60
    s_mov_b32 exec_lo, -1
    s_barrier
    v_xor_b32 v85, 128, v86
    ds_write_b128 v87, v[48:51]
    ds_write_b128 v84, v[56:59]
    ds_write_b32 v85, v52
L_qb:
    s_waitcnt vmcnt(0) lgkmcnt(0)
    s_barrier
L_qc:
    ds_read_b32 v136, v86
    ds_read_b64 v[144:145], v166
    ds_read_b128 v[128:131], v84
    ds_read_b128 v[140:143], v164
    ds_read_b128 v[132:135], v87
    ds_read_b32 v139, v86
    ds_read_b128 v[148:151], v165
    ds_read_b128 v[152:155], v165 offset:608
    ds_read_b128 v[168:171], v164 offset:1024
    s_waitcnt lgkmcnt(7)
    v_mfma_f32_32x32x4_2b_bf16 v[16:47], v[144:145], v[136:137], 0 cbsz:1 abid:0
    s_cmp_lt_u32 s3, 2
    s_cbranch_scc1 L_pollok_b
    s_mov_b32 s56, 0
    s_waitcnt vmcnt(0)
L_poll_b:
    v_cmp_ne_u64 vcc, v[176:177], v[172:173]
    v_cmp_ne_u64 s[32:33], v[178:179], v[172:173]
    s_or_b64 vcc, vcc, s[32:33]
    s_cbranch_vccz L_pollok_b
    s_add_u32 s56, s56, 1
    s_bitcmp1_b32 s56, 18
    s_cbranch_scc1 L_pollok_b
    buffer_load_dwordx4 v[176:179], v180, s[28:31], s57 offen sc1
    s_waitcnt vmcnt(0)
    s_branch L_poll_b
L_pollok_b:
    s_cmp_lt_u32 s3, 2
    s_cselect_b64 vcc, -1, 0
    s_nop 13
    s_waitcnt lgkmcnt(4)
    v_mfma_f32_32x32x16_bf16 v[16:31], v[140:143], v[128:131], v[16:31]
    v_mfma_f32_32x32x16_bf16 v[32:47], v[140:143], v[132:135], v[32:47]
    s_nop 7
    s_nop 3
    s_cmp_eq_u32 s7, 0
    s_cbranch_scc1 L_pr0
    s_setprio 1
L_pr0:
    v_exp_f32 v16, v16
    v_exp_f32 v17, v17
    v_exp_f32 v18, v18
    v_exp_f32 v19, v19
    v_cvt_pk_bf16_f32 v80, v16, v17
    s_waitcnt lgkmcnt(0)
    v_exp_f32 v20, v20
    v_exp_f32 v21, v21
    v_cvt_pk_bf16_f32 v81, v18, v19
    v_exp_f32 v22, v22
    v_mfma_f32_32x32x4_2b_bf16 v[48:79], v[144:145], v[136:137], 0 cbsz:1 abid:1
    v_exp_f32 v23, v23
    v_cvt_pk_bf16_f32 v82, v20, v21
    v_exp_f32 v24, v24
    v_exp_f32 v25, v25
    v_cvt_pk_bf16_f32 v83, v22, v23
    v_exp_f32 v26, v26
    v_exp_f32 v27, v27
    v_cvt_pk_bf16_f32 v84, v24, v25
    v_exp_f32 v28, v28
    v_exp_f32 v29, v29
    v_cvt_pk_bf16_f32 v85, v26, v27
    v_mfma_f32_32x32x16_bf16 v[96:111], v[148:151], v[80:83], 0
    ds_read_b128 v[156:159], v165 offset:1216
    v_exp_f32 v30, v30
    v_exp_f32 v31, v31
    v_cvt_pk_bf16_f32 v86, v28, v29
    s_cbranch_vccnz L_nd0
    s_add_u32 m0, s59, 0
    s_add_u32 s55, s58, 0
    buffer_load_dwordx4 v5, s[28:31], s55 offen offset:0 sc1 lds
    buffer_load_dwordx4 v5, s[28:31], s55 offen offset:1024 sc1 lds
    buffer_load_dwordx4 v5, s[28:31], s55 offen offset:2048 sc1 lds
    buffer_load_dwordx4 v5, s[28:31], s55 offen offset:3072 sc1 lds
L_nd0:
    v_exp_f32 v32, v32
    v_exp_f32 v33, v33
    v_cvt_pk_bf16_f32 v87, v30, v31
    v_mfma_f32_32x32x16_bf16 v[48:63], v[168:171], v[128:131], v[48:63]
    ds_read_b128 v[160:163], v165 offset:1824
    v_exp_f32 v34, v34
    v_exp_f32 v35, v35
    v_cvt_pk_bf16_f32 v88, v32, v33
    v_exp_f32 v36, v36
    v_exp_f32 v37, v37
    v_cvt_pk_bf16_f32 v89, v34, v35
    v_mfma_f32_32x32x16_bf16 v[96:111], v[152:155], v[84:87], v[96:111]
    ds_read_b128 v[140:143], v164 offset:2048
    v_exp_f32 v38, v38
    v_exp_f32 v39, v39
    v_cvt_pk_bf16_f32 v90, v36, v37
    v_exp_f32 v40, v40
    v_exp_f32 v41, v41
    v_cvt_pk_bf16_f32 v91, v38, v39
    s_cbranch_vccnz L_nd1
    s_add_u32 m0, s59, 4096
    s_add_u32 s55, s58, 4096
    buffer_load_dwordx4 v5, s[28:31], s55 offen offset:0 sc1 lds
    buffer_load_dwordx4 v5, s[28:31], s55 offen offset:1024 sc1 lds
    buffer_load_dwordx4 v5, s[28:31], s55 offen offset:2048 sc1 lds
    buffer_load_dwordx4 v5, s[28:31], s55 offen offset:3072 sc1 lds
L_nd1:
    v_exp_f32 v42, v42
    v_exp_f32 v43, v43
    v_cvt_pk_bf16_f32 v92, v40, v41
    v_mfma_f32_32x32x16_bf16 v[112:127], v[148:151], v[88:91], 0
    v_exp_f32 v44, v44
    v_exp_f32 v45, v45
    v_cvt_pk_bf16_f32 v93, v42, v43
    v_exp_f32 v46, v46
    v_mfma_f32_32x32x16_bf16 v[64:79], v[168:171], v[132:135], v[64:79]
    v_exp_f32 v47, v47
    v_cvt_pk_bf16_f32 v94, v44, v45
    v_exp_f32 v48, v48
    v_exp_f32 v49, v49
    v_cvt_pk_bf16_f32 v95, v46, v47
    v_exp_f32 v50, v50
    v_exp_f32 v51, v51
    v_cvt_pk_bf16_f32 v80, v48, v49
    v_mfma_f32_32x32x16_bf16 v[112:127], v[152:155], v[92:95], v[112:127]
    s_waitcnt lgkmcnt(0)
    v_exp_f32 v52, v52
    v_exp_f32 v53, v53
    v_cvt_pk_bf16_f32 v81, v50, v51
    v_exp_f32 v54, v54
    v_mfma_f32_32x32x4_2b_bf16 v[16:47], v[144:145], v[138:139], 0 cbsz:1 abid:0
    v_exp_f32 v55, v55
    v_cvt_pk_bf16_f32 v82, v52, v53
    v_exp_f32 v56, v56
    v_exp_f32 v57, v57
    v_cvt_pk_bf16_f32 v83, v54, v55
    v_exp_f32 v58, v58
    v_exp_f32 v59, v59
    v_cvt_pk_bf16_f32 v84, v56, v57
    v_exp_f32 v60, v60
    v_exp_f32 v61, v61
    v_cvt_pk_bf16_f32 v85, v58, v59
    v_mfma_f32_32x32x16_bf16 v[96:111], v[156:159], v[80:83], v[96:111]
    ds_read_b128 v[148:151], v165 offset:2432
    v_exp_f32 v62, v62
    v_exp_f32 v63, v63
    v_cvt_pk_bf16_f32 v86, v60, v61
    s_cbranch_vccnz L_nd2
    s_add_u32 m0, s59, 8192
    s_add_u32 s55, s58, 8192
    buffer_load_dwordx4 v5, s[28:31], s55 offen offset:0 sc1 lds
    buffer_load_dwordx4 v5, s[28:31], s55 offen offset:1024 sc1 lds
    buffer_load_dwordx4 v5, s[28:31], s55 offen offset:2048 sc1 lds
    buffer_load_dwordx4 v5, s[28:31], s55 offen offset:3072 sc1 lds
L_nd2:
    v_exp_f32 v64, v64
    v_exp_f32 v65, v65
    v_cvt_pk_bf16_f32 v87, v62, v63
    v_mfma_f32_32x32x16_bf16 v[16:31], v[140:143], v[128:131], v[16:31]
    ds_read_b128 v[152:155], v165 offset:3040
    v_exp_f32 v66, v66
    v_exp_f32 v67, v67
    v_cvt_pk_bf16_f32 v88, v64, v65
    v_exp_f32 v68, v68
    v_exp_f32 v69, v69
    v_cvt_pk_bf16_f32 v89, v66, v67
    v_mfma_f32_32x32x16_bf16 v[96:111], v[160:163], v[84:87], v[96:111]
    ds_read_b128 v[168:171], v164 offset:3072
    v_exp_f32 v70, v70
    v_exp_f32 v71, v71
    v_cvt_pk_bf16_f32 v90, v68, v69
    v_exp_f32 v72, v72
    v_exp_f32 v73, v73
    v_cvt_pk_bf16_f32 v91, v70, v71
    s_cbranch_vccnz L_nd3
    s_add_u32 m0, s59, 12288
    s_add_u32 s55, s58, 12288
    buffer_load_dwordx4 v5, s[28:31], s55 offen offset:0 sc1 lds
    buffer_load_dwordx4 v5, s[28:31], s55 offen offset:1024 sc1 lds
    buffer_load_dwordx4 v5, s[28:31], s55 offen offset:2048 sc1 lds
    buffer_load_dwordx4 v5, s[28:31], s55 offen offset:3072 sc1 lds
L_nd3:
    v_exp_f32 v74, v74
    v_exp_f32 v75, v75
    v_cvt_pk_bf16_f32 v92, v72, v73
    v_mfma_f32_32x32x16_bf16 v[112:127], v[156:159], v[88:91], v[112:127]
    ds_read_b64 v[146:147], v166 offset:19456
    v_exp_f32 v76, v76
    v_exp_f32 v77, v77
    v_cvt_pk_bf16_f32 v93, v74, v75
    v_exp_f32 v78, v78
    v_mfma_f32_32x32x16_bf16 v[32:47], v[140:143], v[132:135], v[32:47]
    v_exp_f32 v79, v79
    v_cvt_pk_bf16_f32 v94, v76, v77
    v_exp_f32 v16, v16
    v_exp_f32 v17, v17
    v_cvt_pk_bf16_f32 v95, v78, v79
    v_exp_f32 v18, v18
    v_exp_f32 v19, v19
    v_cvt_pk_bf16_f32 v80, v16, v17
    v_mfma_f32_32x32x16_bf16 v[112:127], v[160:163], v[92:95], v[112:127]
    s_waitcnt lgkmcnt(0)
    v_exp_f32 v20, v20
    v_exp_f32 v21, v21
    v_cvt_pk_bf16_f32 v81, v18, v19
    v_exp_f32 v22, v22
    v_mfma_f32_32x32x4_2b_bf16 v[48:79], v[144:145], v[138:139], 0 cbsz:1 abid:1
    v_exp_f32 v23, v23
    v_cvt_pk_bf16_f32 v82, v20, v21
    v_exp_f32 v24, v24
    v_exp_f32 v25, v25
    v_cvt_pk_bf16_f32 v83, v22, v23
    v_exp_f32 v26, v26
    v_exp_f32 v27, v27
    v_cvt_pk_bf16_f32 v84, v24, v25
    v_exp_f32 v28, v28
    v_exp_f32 v29, v29
    v_cvt_pk_bf16_f32 v85, v26, v27
    v_mfma_f32_32x32x16_bf16 v[96:111], v[148:151], v[80:83], v[96:111]
    ds_read_b128 v[156:159], v165 offset:3648
    v_exp_f32 v30, v30
    v_exp_f32 v31, v31
    v_cvt_pk_bf16_f32 v86, v28, v29
    s_cbranch_vccnz L_nd4
    s_add_u32 m0, s59, 16384
    s_add_u32 s55, s58, 16384
    buffer_load_dwordx4 v5, s[28:31], s55 offen offset:0 sc1 lds
    buffer_load_dwordx4 v5, s[28:31], s55 offen offset:1024 sc1 lds
    s_mov_b32 exec_hi, 0
    buffer_load_dwordx4 v5, s[28:31], s55 offen offset:2048 sc1 lds
    s_mov_b32 exec_hi, -1
L_nd4:
    v_exp_f32 v32, v32
    v_exp_f32 v33, v33
    v_cvt_pk_bf16_f32 v87, v30, v31
    v_mfma_f32_32x32x16_bf16 v[48:63], v[168:171], v[128:131], v[48:63]
    ds_read_b128 v[160:163], v165 offset:4256
    v_exp_f32 v34, v34
    v_exp_f32 v35, v35
    v_cvt_pk_bf16_f32 v88, v32, v33
    v_exp_f32 v36, v36
    v_exp_f32 v37, v37
    v_cvt_pk_bf16_f32 v89, v34, v35
    v_mfma_f32_32x32x16_bf16 v[96:111], v[152:155], v[84:87], v[96:111]
    ds_read_b128 v[140:143], v164 offset:19456
    v_exp_f32 v38, v38
    v_exp_f32 v39, v39
    v_cvt_pk_bf16_f32 v90, v36, v37
    v_exp_f32 v40, v40
    v_exp_f32 v41, v41
    v_cvt_pk_bf16_f32 v91, v38, v39
    v_exp_f32 v42, v42
    v_exp_f32 v43, v43
    v_cvt_pk_bf16_f32 v92, v40, v41
    v_mfma_f32_32x32x16_bf16 v[112:127], v[148:151], v[88:91], v[112:127]
    v_exp_f32 v44, v44
    v_exp_f32 v45, v45
    v_cvt_pk_bf16_f32 v93, v42, v43
    v_exp_f32 v46, v46
    v_mfma_f32_32x32x16_bf16 v[64:79], v[168:171], v[132:135], v[64:79]
    v_exp_f32 v47, v47
    v_cvt_pk_bf16_f32 v94, v44, v45
    v_exp_f32 v48, v48
    v_exp_f32 v49, v49
    v_cvt_pk_bf16_f32 v95, v46, v47
    v_exp_f32 v50, v50
    v_exp_f32 v51, v51
    v_cvt_pk_bf16_f32 v80, v48, v49
    v_mfma_f32_32x32x16_bf16 v[112:127], v[152:155], v[92:95], v[112:127]
    s_waitcnt lgkmcnt(0)
    v_exp_f32 v52, v52
    v_exp_f32 v53, v53
    v_cvt_pk_bf16_f32 v81, v50, v51
    v_exp_f32 v54, v54
    v_mfma_f32_32x32x4_2b_bf16 v[16:47], v[146:147], v[136:137], 0 cbsz:1 abid:0
    v_exp_f32 v55, v55
    v_cvt_pk_bf16_f32 v82, v52, v53
    v_exp_f32 v56, v56
    v_exp_f32 v57, v57
    v_cvt_pk_bf16_f32 v83, v54, v55
    v_exp_f32 v58, v58
    v_exp_f32 v59, v59
    v_cvt_pk_bf16_f32 v84, v56, v57
    v_exp_f32 v60, v60
    v_exp_f32 v61, v61
    v_cvt_pk_bf16_f32 v85, v58, v59
    v_mfma_f32_32x32x16_bf16 v[96:111], v[156:159], v[80:83], v[96:111]
    ds_read_b128 v[148:151], v165 offset:19456
    v_exp_f32 v62, v62
    v_exp_f32 v63, v63
    v_cvt_pk_bf16_f32 v86, v60, v61
    v_exp_f32 v64, v64
    v_exp_f32 v65, v65
    v_cvt_pk_bf16_f32 v87, v62, v63
    v_mfma_f32_32x32x16_bf16 v[16:31], v[140:143], v[128:131], v[16:31]
    ds_read_b128 v[152:155], v165 offset:20064
    v_exp_f32 v66, v66
    v_exp_f32 v67, v67
    v_cvt_pk_bf16_f32 v88, v64, v65
    v_exp_f32 v68, v68
    v_exp_f32 v69, v69
    v_cvt_pk_bf16_f32 v89, v66, v67
    v_mfma_f32_32x32x16_bf16 v[96:111], v[160:163], v[84:87], v[96:111]
    ds_read_b128 v[168:171], v164 offset:20480
    v_exp_f32 v70, v70
    v_exp_f32 v71, v71
    v_cvt_pk_bf16_f32 v90, v68, v69
    v_exp_f32 v72, v72
    v_exp_f32 v73, v73
    v_cvt_pk_bf16_f32 v91, v70, v71
    v_exp_f32 v74, v74
    v_exp_f32 v75, v75
    v_cvt_pk_bf16_f32 v92, v72, v73
    v_mfma_f32_32x32x16_bf16 v[112:127], v[156:159], v[88:91], v[112:127]
    v_exp_f32 v76, v76
    v_exp_f32 v77, v77
    v_cvt_pk_bf16_f32 v93, v74, v75
    v_exp_f32 v78, v78
    v_mfma_f32_32x32x16_bf16 v[32:47], v[140:143], v[132:135], v[32:47]
    v_exp_f32 v79, v79
    v_cvt_pk_bf16_f32 v94, v76, v77
    s_setprio 0
    v_exp_f32 v16, v16
    v_exp_f32 v17, v17
    v_cvt_pk_bf16_f32 v95, v78, v79
    v_exp_f32 v18, v18
    v_exp_f32 v19, v19
    v_cvt_pk_bf16_f32 v80, v16, v17
    v_mfma_f32_32x32x16_bf16 v[112:127], v[160:163], v[92:95], v[112:127]
    s_waitcnt lgkmcnt(0)
    v_exp_f32 v20, v20
    v_exp_f32 v21, v21
    v_cvt_pk_bf16_f32 v81, v18, v19
    v_exp_f32 v22, v22
    v_mfma_f32_32x32x4_2b_bf16 v[48:79], v[146:147], v[136:137], 0 cbsz:1 abid:1
    v_exp_f32 v23, v23
    v_cvt_pk_bf16_f32 v82, v20, v21
    v_exp_f32 v24, v24
    v_exp_f32 v25, v25
    v_cvt_pk_bf16_f32 v83, v22, v23
    v_exp_f32 v26, v26
    v_exp_f32 v27, v27
    v_cvt_pk_bf16_f32 v84, v24, v25
    v_exp_f32 v28, v28
    v_exp_f32 v29, v29
    v_cvt_pk_bf16_f32 v85, v26, v27
    v_mfma_f32_32x32x16_bf16 v[96:111], v[148:151], v[80:83], v[96:111]
    ds_read_b128 v[156:159], v165 offset:20672
    v_exp_f32 v30, v30
    v_exp_f32 v31, v31
    v_cvt_pk_bf16_f32 v86, v28, v29
    v_exp_f32 v32, v32
    v_exp_f32 v33, v33
    v_cvt_pk_bf16_f32 v87, v30, v31
    v_mfma_f32_32x32x16_bf16 v[48:63], v[168:171], v[128:131], v[48:63]
    ds_read_b128 v[160:163], v165 offset:21280
    v_exp_f32 v34, v34
    v_exp_f32 v35, v35
    v_cvt_pk_bf16_f32 v88, v32, v33
    v_exp_f32 v36, v36
    v_exp_f32 v37, v37
    v_cvt_pk_bf16_f32 v89, v34, v35
    v_mfma_f32_32x32x16_bf16 v[96:111], v[152:155], v[84:87], v[96:111]
    ds_read_b128 v[140:143], v164 offset:21504
    v_exp_f32 v38, v38
    v_exp_f32 v39, v39
    v_cvt_pk_bf16_f32 v90, v36, v37
    v_exp_f32 v40, v40
    v_exp_f32 v41, v41
    v_cvt_pk_bf16_f32 v91, v38, v39
    v_exp_f32 v42, v42
    v_exp_f32 v43, v43
    v_cvt_pk_bf16_f32 v92, v40, v41
    v_mfma_f32_32x32x16_bf16 v[112:127], v[148:151], v[88:91], v[112:127]
    v_exp_f32 v44, v44
    v_exp_f32 v45, v45
    v_cvt_pk_bf16_f32 v93, v42, v43
    v_exp_f32 v46, v46
    v_mfma_f32_32x32x16_bf16 v[64:79], v[168:171], v[132:135], v[64:79]
    v_exp_f32 v47, v47
    v_cvt_pk_bf16_f32 v94, v44, v45
    s_waitcnt vmcnt(0)
    s_barrier
    s_cmp_eq_u32 s7, 0
    s_cbranch_scc1 L_pr5
    s_setprio 1
L_pr5:
    v_exp_f32 v48, v48
    v_exp_f32 v49, v49
    v_cvt_pk_bf16_f32 v95, v46, v47
    v_exp_f32 v50, v50
    v_exp_f32 v51, v51
    v_cvt_pk_bf16_f32 v80, v48, v49
    v_mfma_f32_32x32x16_bf16 v[112:127], v[152:155], v[92:95], v[112:127]
    s_waitcnt lgkmcnt(0)
    v_exp_f32 v52, v52
    v_exp_f32 v53, v53
    v_cvt_pk_bf16_f32 v81, v50, v51
    v_exp_f32 v54, v54
    v_mfma_f32_32x32x4_2b_bf16 v[16:47], v[146:147], v[138:139], 0 cbsz:1 abid:0
    v_exp_f32 v55, v55
    v_cvt_pk_bf16_f32 v82, v52, v53
    v_exp_f32 v56, v56
    v_exp_f32 v57, v57
    v_cvt_pk_bf16_f32 v83, v54, v55
    v_exp_f32 v58, v58
    v_exp_f32 v59, v59
    v_cvt_pk_bf16_f32 v84, v56, v57
    v_exp_f32 v60, v60
    v_exp_f32 v61, v61
    v_cvt_pk_bf16_f32 v85, v58, v59
    v_mfma_f32_32x32x16_bf16 v[96:111], v[156:159], v[80:83], v[96:111]
    ds_read_b128 v[148:151], v165 offset:21888
    v_exp_f32 v62, v62
    v_exp_f32 v63, v63
    v_cvt_pk_bf16_f32 v86, v60, v61
    v_exp_f32 v64, v64
    v_exp_f32 v65, v65
    v_cvt_pk_bf16_f32 v87, v62, v63
    v_mfma_f32_32x32x16_bf16 v[16:31], v[140:143], v[128:131], v[16:31]
    ds_read_b128 v[152:155], v165 offset:22496
    v_exp_f32 v66, v66
    v_exp_f32 v67, v67
    v_cvt_pk_bf16_f32 v88, v64, v65
    v_exp_f32 v68, v68
    v_exp_f32 v69, v69
    v_cvt_pk_bf16_f32 v89, v66, v67
    v_mfma_f32_32x32x16_bf16 v[96:111], v[160:163], v[84:87], v[96:111]
    ds_read_b128 v[168:171], v164 offset:22528
    v_exp_f32 v70, v70
    v_exp_f32 v71, v71
    v_cvt_pk_bf16_f32 v90, v68, v69
    v_exp_f32 v72, v72
    v_exp_f32 v73, v73
    v_cvt_pk_bf16_f32 v91, v70, v71
    v_exp_f32 v74, v74
    v_exp_f32 v75, v75
    v_cvt_pk_bf16_f32 v92, v72, v73
    v_mfma_f32_32x32x16_bf16 v[112:127], v[156:159], v[88:91], v[112:127]
    ds_read_b64 v[144:145], v166 offset:38912
    v_exp_f32 v76, v76
    v_exp_f32 v77, v77
    v_cvt_pk_bf16_f32 v93, v74, v75
    v_exp_f32 v78, v78
    v_mfma_f32_32x32x16_bf16 v[32:47], v[140:143], v[132:135], v[32:47]
    v_exp_f32 v79, v79
    v_cvt_pk_bf16_f32 v94, v76, v77
    v_exp_f32 v16, v16
    v_exp_f32 v17, v17
    v_cvt_pk_bf16_f32 v95, v78, v79
    v_exp_f32 v18, v18
    v_exp_f32 v19, v19
    v_cvt_pk_bf16_f32 v80, v16, v17
    v_mfma_f32_32x32x16_bf16 v[112:127], v[160:163], v[92:95], v[112:127]
    s_waitcnt lgkmcnt(0)
    v_exp_f32 v20, v20
    v_exp_f32 v21, v21
    v_cvt_pk_bf16_f32 v81, v18, v19
    v_exp_f32 v22, v22
    v_mfma_f32_32x32x4_2b_bf16 v[48:79], v[146:147], v[138:139], 0 cbsz:1 abid:1
    v_exp_f32 v23, v23
    v_cvt_pk_bf16_f32 v82, v20, v21
    v_exp_f32 v24, v24
    v_exp_f32 v25, v25
    v_cvt_pk_bf16_f32 v83, v22, v23
    v_exp_f32 v26, v26
    v_exp_f32 v27, v27
    v_cvt_pk_bf16_f32 v84, v24, v25
    v_exp_f32 v28, v28
    v_exp_f32 v29, v29
    v_cvt_pk_bf16_f32 v85, v26, v27
    v_mfma_f32_32x32x16_bf16 v[96:111], v[148:151], v[80:83], v[96:111]
    ds_read_b128 v[156:159], v165 offset:23104
    v_exp_f32 v30, v30
    v_exp_f32 v31, v31
    v_cvt_pk_bf16_f32 v86, v28, v29
    v_exp_f32 v32, v32
    v_exp_f32 v33, v33
    v_cvt_pk_bf16_f32 v87, v30, v31
    v_mfma_f32_32x32x16_bf16 v[48:63], v[168:171], v[128:131], v[48:63]
    ds_read_b128 v[160:163], v165 offset:23712
    v_exp_f32 v34, v34
    v_exp_f32 v35, v35
    v_cvt_pk_bf16_f32 v88, v32, v33
    v_exp_f32 v36, v36
    v_exp_f32 v37, v37
    v_cvt_pk_bf16_f32 v89, v34, v35
    v_mfma_f32_32x32x16_bf16 v[96:111], v[152:155], v[84:87], v[96:111]
    ds_read_b128 v[140:143], v164 offset:38912
    v_exp_f32 v38, v38
    v_exp_f32 v39, v39
    v_cvt_pk_bf16_f32 v90, v36, v37
    v_exp_f32 v40, v40
    v_exp_f32 v41, v41
    v_cvt_pk_bf16_f32 v91, v38, v39
    v_exp_f32 v42, v42
    v_exp_f32 v43, v43
    v_cvt_pk_bf16_f32 v92, v40, v41
    v_mfma_f32_32x32x16_bf16 v[112:127], v[148:151], v[88:91], v[112:127]
    v_exp_f32 v44, v44
    v_exp_f32 v45, v45
    v_cvt_pk_bf16_f32 v93, v42, v43
    v_exp_f32 v46, v46
    v_mfma_f32_32x32x16_bf16 v[64:79], v[168:171], v[132:135], v[64:79]
    v_exp_f32 v47, v47
    v_cvt_pk_bf16_f32 v94, v44, v45
    v_exp_f32 v48, v48
    v_exp_f32 v49, v49
    v_cvt_pk_bf16_f32 v95, v46, v47
    v_exp_f32 v50, v50
    v_exp_f32 v51, v51
    v_cvt_pk_bf16_f32 v80, v48, v49
    v_mfma_f32_32x32x16_bf16 v[112:127], v[152:155], v[92:95], v[112:127]
    s_waitcnt lgkmcnt(0)
    v_exp_f32 v52, v52
    v_exp_f32 v53, v53
    v_cvt_pk_bf16_f32 v81, v50, v51
    v_exp_f32 v54, v54
    v_mfma_f32_32x32x4_2b_bf16 v[16:47], v[144:145], v[136:137], 0 cbsz:1 abid:0
    v_exp_f32 v55, v55
    v_cvt_pk_bf16_f32 v82, v52, v53
    v_exp_f32 v56, v56
    v_exp_f32 v57, v57
    v_cvt_pk_bf16_f32 v83, v54, v55
    v_exp_f32 v58, v58
    v_exp_f32 v59, v59
    v_cvt_pk_bf16_f32 v84, v56, v57
    v_exp_f32 v60, v60
    v_exp_f32 v61, v61
    v_cvt_pk_bf16_f32 v85, v58, v59
    v_mfma_f32_32x32x16_bf16 v[96:111], v[156:159], v[80:83], v[96:111]
    ds_read_b128 v[148:151], v165 offset:38912
    v_exp_f32 v62, v62
    v_exp_f32 v63, v63
    v_cvt_pk_bf16_f32 v86, v60, v61
    s_lshl_b32 s54, s4, 3
    s_add_u32 s54, s54, s5
    s_mul_i32 s54, s54, 9216
    s_add_u32 s54, s54, 262144
    s_lshl_b32 s35, s3, 10
    s_add_u32 s55, s54, s35
    s_lshl_b32 s35, s3, 7
    s_add_u32 s54, s54, s35
    s_add_u32 s54, s54, 8192
    v_mov_b32 v252, -1
    v_mov_b32 v253, -1
    v_mov_b32 v254, -1
    v_mov_b32 v255, -1
    v_exp_f32 v64, v64
    v_exp_f32 v65, v65
    v_cvt_pk_bf16_f32 v87, v62, v63
    v_mfma_f32_32x32x16_bf16 v[16:31], v[140:143], v[128:131], v[16:31]
    ds_read_b128 v[152:155], v165 offset:39520
    v_exp_f32 v66, v66
    v_exp_f32 v67, v67
    v_cvt_pk_bf16_f32 v88, v64, v65
    v_exp_f32 v68, v68
    v_exp_f32 v69, v69
    v_cvt_pk_bf16_f32 v89, v66, v67
    v_mfma_f32_32x32x16_bf16 v[96:111], v[160:163], v[84:87], v[96:111]
    ds_read_b128 v[168:171], v164 offset:39936
    v_exp_f32 v70, v70
    v_exp_f32 v71, v71
    v_cvt_pk_bf16_f32 v90, v68, v69
    v_exp_f32 v72, v72
    v_exp_f32 v73, v73
    v_cvt_pk_bf16_f32 v91, v70, v71
    buffer_store_dwordx4 v[252:255], v5, s[28:31], s55 offen sc1
    s_mov_b64 exec, 0xff
    buffer_store_dwordx4 v[252:255], v5, s[28:31], s54 offen sc1
    s_mov_b64 exec, -1
    v_exp_f32 v74, v74
    v_exp_f32 v75, v75
    v_cvt_pk_bf16_f32 v92, v72, v73
    v_mfma_f32_32x32x16_bf16 v[112:127], v[156:159], v[88:91], v[112:127]
    v_exp_f32 v76, v76
    v_exp_f32 v77, v77
    v_cvt_pk_bf16_f32 v93, v74, v75
    v_exp_f32 v78, v78
    v_mfma_f32_32x32x16_bf16 v[32:47], v[140:143], v[132:135], v[32:47]
    v_exp_f32 v79, v79
    v_cvt_pk_bf16_f32 v94, v76, v77
    v_add_u32 v164, 38912, v164
    v_add_u32 v165, 38912, v165
    v_add_u32 v166, 38912, v166
    v_exp_f32 v16, v16
    v_exp_f32 v17, v17
    v_cvt_pk_bf16_f32 v95, v78, v79
    v_exp_f32 v18, v18
    v_exp_f32 v19, v19
    v_cvt_pk_bf16_f32 v80, v16, v17
    v_mfma_f32_32x32x16_bf16 v[112:127], v[160:163], v[92:95], v[112:127]
    s_waitcnt lgkmcnt(0)
    v_exp_f32 v20, v20
    v_exp_f32 v21, v21
    v_cvt_pk_bf16_f32 v81, v18, v19
    v_exp_f32 v22, v22
    v_mfma_f32_32x32x4_2b_bf16 v[48:79], v[144:145], v[136:137], 0 cbsz:1 abid:1
    v_exp_f32 v23, v23
    v_cvt_pk_bf16_f32 v82, v20, v21
    v_exp_f32 v24, v24
    v_exp_f32 v25, v25
    v_cvt_pk_bf16_f32 v83, v22, v23
    v_exp_f32 v26, v26
    v_exp_f32 v27, v27
    v_cvt_pk_bf16_f32 v84, v24, v25
    v_exp_f32 v28, v28
    v_exp_f32 v29, v29
    v_cvt_pk_bf16_f32 v85, v26, v27
    v_mfma_f32_32x32x16_bf16 v[96:111], v[148:151], v[80:83], v[96:111]
    ds_read_b128 v[156:159], v165 offset:1216
    v_exp_f32 v30, v30
    v_exp_f32 v31, v31
    v_cvt_pk_bf16_f32 v86, v28, v29
    v_exp_f32 v32, v32
    v_exp_f32 v33, v33
    v_cvt_pk_bf16_f32 v87, v30, v31
    v_mfma_f32_32x32x16_bf16 v[48:63], v[168:171], v[128:131], v[48:63]
    ds_read_b128 v[160:163], v165 offset:1824
    v_exp_f32 v34, v34
    v_exp_f32 v35, v35
    v_cvt_pk_bf16_f32 v88, v32, v33
    v_exp_f32 v36, v36
    v_exp_f32 v37, v37
    v_cvt_pk_bf16_f32 v89, v34, v35
    v_mfma_f32_32x32x16_bf16 v[96:111], v[152:155], v[84:87], v[96:111]
    ds_read_b128 v[140:143], v164 offset:2048
    v_exp_f32 v38, v38
    v_exp_f32 v39, v39
    v_cvt_pk_bf16_f32 v90, v36, v37
    v_exp_f32 v40, v40
    v_exp_f32 v41, v41
    v_cvt_pk_bf16_f32 v91, v38, v39
    v_exp_f32 v42, v42
    v_exp_f32 v43, v43
    v_cvt_pk_bf16_f32 v92, v40, v41
    v_mfma_f32_32x32x16_bf16 v[112:127], v[148:151], v[88:91], v[112:127]
    v_exp_f32 v44, v44
    v_exp_f32 v45, v45
    v_cvt_pk_bf16_f32 v93, v42, v43
    v_exp_f32 v46, v46
    v_mfma_f32_32x32x16_bf16 v[64:79], v[168:171], v[132:135], v[64:79]
    v_exp_f32 v47, v47
    v_cvt_pk_bf16_f32 v94, v44, v45
    v_exp_f32 v48, v48
    v_exp_f32 v49, v49
    v_cvt_pk_bf16_f32 v95, v46, v47
    v_exp_f32 v50, v50
    v_exp_f32 v51, v51
    v_cvt_pk_bf16_f32 v80, v48, v49
    v_mfma_f32_32x32x16_bf16 v[112:127], v[152:155], v[92:95], v[112:127]
    s_waitcnt lgkmcnt(0)
    v_exp_f32 v52, v52
    v_exp_f32 v53, v53
    v_cvt_pk_bf16_f32 v81, v50, v51
    v_exp_f32 v54, v54
    v_mfma_f32_32x32x4_2b_bf16 v[16:47], v[144:145], v[138:139], 0 cbsz:1 abid:0
    v_exp_f32 v55, v55
    v_cvt_pk_bf16_f32 v82, v52, v53
    v_exp_f32 v56, v56
    v_exp_f32 v57, v57
    v_cvt_pk_bf16_f32 v83, v54, v55
    v_exp_f32 v58, v58
    v_exp_f32 v59, v59
    v_cvt_pk_bf16_f32 v84, v56, v57
    v_exp_f32 v60, v60
    v_exp_f32 v61, v61
    v_cvt_pk_bf16_f32 v85, v58, v59
    v_mfma_f32_32x32x16_bf16 v[96:111], v[156:159], v[80:83], v[96:111]
    ds_read_b128 v[148:151], v165 offset:2432
    v_exp_f32 v62, v62
    v_exp_f32 v63, v63
    v_cvt_pk_bf16_f32 v86, v60, v61
    v_exp_f32 v64, v64
    v_exp_f32 v65, v65
    v_cvt_pk_bf16_f32 v87, v62, v63
    v_mfma_f32_32x32x16_bf16 v[16:31], v[140:143], v[128:131], v[16:31]
    ds_read_b128 v[152:155], v165 offset:3040
    v_exp_f32 v66, v66
    v_exp_f32 v67, v67
    v_cvt_pk_bf16_f32 v88, v64, v65
    v_exp_f32 v68, v68
    v_exp_f32 v69, v69
    v_cvt_pk_bf16_f32 v89, v66, v67
    v_mfma_f32_32x32x16_bf16 v[96:111], v[160:163], v[84:87], v[96:111]
    ds_read_b128 v[168:171], v164 offset:3072
    v_exp_f32 v70, v70
    v_exp_f32 v71, v71
    v_cvt_pk_bf16_f32 v90, v68, v69
    v_exp_f32 v72, v72
    v_exp_f32 v73, v73
    v_cvt_pk_bf16_f32 v91, v70, v71
    v_exp_f32 v74, v74
    v_exp_f32 v75, v75
    v_cvt_pk_bf16_f32 v92, v72, v73
    v_mfma_f32_32x32x16_bf16 v[112:127], v[156:159], v[88:91], v[112:127]
    ds_read_b64 v[146:147], v166 offset:19456
    v_exp_f32 v76, v76
    v_exp_f32 v77, v77
    v_cvt_pk_bf16_f32 v93, v74, v75
    v_exp_f32 v78, v78
    v_mfma_f32_32x32x16_bf16 v[32:47], v[140:143], v[132:135], v[32:47]
    v_exp_f32 v79, v79
    v_cvt_pk_bf16_f32 v94, v76, v77
    v_exp_f32 v16, v16
    v_exp_f32 v17, v17
    v_cvt_pk_bf16_f32 v95, v78, v79
    v_exp_f32 v18, v18
    v_exp_f32 v19, v19
    v_cvt_pk_bf16_f32 v80, v16, v17
    v_mfma_f32_32x32x16_bf16 v[112:127], v[160:163], v[92:95], v[112:127]
    s_waitcnt lgkmcnt(0)
    v_exp_f32 v20, v20
    v_exp_f32 v21, v21
    v_cvt_pk_bf16_f32 v81, v18, v19
    v_exp_f32 v22, v22
    v_mfma_f32_32x32x4_2b_bf16 v[48:79], v[144:145], v[138:139], 0 cbsz:1 abid:1
    v_exp_f32 v23, v23
    v_cvt_pk_bf16_f32 v82, v20, v21
    v_exp_f32 v24, v24
    v_exp_f32 v25, v25
    v_cvt_pk_bf16_f32 v83, v22, v23
    v_exp_f32 v26, v26
    v_exp_f32 v27, v27
    v_cvt_pk_bf16_f32 v84, v24, v25
    v_exp_f32 v28, v28
    v_exp_f32 v29, v29
    v_cvt_pk_bf16_f32 v85, v26, v27
    v_mfma_f32_32x32x16_bf16 v[96:111], v[148:151], v[80:83], v[96:111]
    ds_read_b128 v[156:159], v165 offset:3648
    v_exp_f32 v30, v30
    v_exp_f32 v31, v31
    v_cvt_pk_bf16_f32 v86, v28, v29
    v_exp_f32 v32, v32
    v_exp_f32 v33, v33
    v_cvt_pk_bf16_f32 v87, v30, v31
    v_mfma_f32_32x32x16_bf16 v[48:63], v[168:171], v[128:131], v[48:63]
    ds_read_b128 v[160:163], v165 offset:4256
    v_exp_f32 v34, v34
    v_exp_f32 v35, v35
    v_cvt_pk_bf16_f32 v88, v32, v33
    v_exp_f32 v36, v36
    v_exp_f32 v37, v37
    v_cvt_pk_bf16_f32 v89, v34, v35
    v_mfma_f32_32x32x16_bf16 v[96:111], v[152:155], v[84:87], v[96:111]
    ds_read_b128 v[140:143], v164 offset:19456
    v_exp_f32 v38, v38
    v_exp_f32 v39, v39
    v_cvt_pk_bf16_f32 v90, v36, v37
    v_exp_f32 v40, v40
    v_exp_f32 v41, v41
    v_cvt_pk_bf16_f32 v91, v38, v39
    v_exp_f32 v42, v42
    v_exp_f32 v43, v43
    v_cvt_pk_bf16_f32 v92, v40, v41
    v_mfma_f32_32x32x16_bf16 v[112:127], v[148:151], v[88:91], v[112:127]
    v_exp_f32 v44, v44
    v_exp_f32 v45, v45
    v_cvt_pk_bf16_f32 v93, v42, v43
    v_exp_f32 v46, v46
    v_mfma_f32_32x32x16_bf16 v[64:79], v[168:171], v[132:135], v[64:79]
    v_exp_f32 v47, v47
    v_cvt_pk_bf16_f32 v94, v44, v45
    v_exp_f32 v48, v48
    v_exp_f32 v49, v49
    v_cvt_pk_bf16_f32 v95, v46, v47
    v_exp_f32 v50, v50
    v_exp_f32 v51, v51
    v_cvt_pk_bf16_f32 v80, v48, v49
    v_mfma_f32_32x32x16_bf16 v[112:127], v[152:155], v[92:95], v[112:127]
    s_waitcnt lgkmcnt(0)
    v_exp_f32 v52, v52
    v_exp_f32 v53, v53
    v_cvt_pk_bf16_f32 v81, v50, v51
    v_exp_f32 v54, v54
    v_mfma_f32_32x32x4_2b_bf16 v[16:47], v[146:147], v[136:137], 0 cbsz:1 abid:0
    v_exp_f32 v55, v55
    v_cvt_pk_bf16_f32 v82, v52, v53
    v_exp_f32 v56, v56
    v_exp_f32 v57, v57
    v_cvt_pk_bf16_f32 v83, v54, v55
    v_exp_f32 v58, v58
    v_exp_f32 v59, v59
    v_cvt_pk_bf16_f32 v84, v56, v57
    v_exp_f32 v60, v60
    v_exp_f32 v61, v61
    v_cvt_pk_bf16_f32 v85, v58, v59
    v_mfma_f32_32x32x16_bf16 v[96:111], v[156:159], v[80:83], v[96:111]
    ds_read_b128 v[148:151], v165 offset:19456
    v_exp_f32 v62, v62
    v_exp_f32 v63, v63
    v_cvt_pk_bf16_f32 v86, v60, v61
    v_exp_f32 v64, v64
    v_exp_f32 v65, v65
    v_cvt_pk_bf16_f32 v87, v62, v63
    v_mfma_f32_32x32x16_bf16 v[16:31], v[140:143], v[128:131], v[16:31]
    ds_read_b128 v[152:155], v165 offset:20064
    v_exp_f32 v66, v66
    v_exp_f32 v67, v67
    v_cvt_pk_bf16_f32 v88, v64, v65
    v_exp_f32 v68, v68
    v_exp_f32 v69, v69
    v_cvt_pk_bf16_f32 v89, v66, v67
    v_mfma_f32_32x32x16_bf16 v[96:111], v[160:163], v[84:87], v[96:111]
    ds_read_b128 v[168:171], v164 offset:20480
    v_exp_f32 v70, v70
    v_exp_f32 v71, v71
    v_cvt_pk_bf16_f32 v90, v68, v69
    v_exp_f32 v72, v72
    v_exp_f32 v73, v73
    v_cvt_pk_bf16_f32 v91, v70, v71
    v_exp_f32 v74, v74
    v_exp_f32 v75, v75
    v_cvt_pk_bf16_f32 v92, v72, v73
    v_mfma_f32_32x32x16_bf16 v[112:127], v[156:159], v[88:91], v[112:127]
    v_exp_f32 v76, v76
    v_exp_f32 v77, v77
    v_cvt_pk_bf16_f32 v93, v74, v75
    v_exp_f32 v78, v78
    v_mfma_f32_32x32x16_bf16 v[32:47], v[140:143], v[132:135], v[32:47]
    v_exp_f32 v79, v79
    v_cvt_pk_bf16_f32 v94, v76, v77
    v_exp_f32 v16, v16
    v_exp_f32 v17, v17
    v_cvt_pk_bf16_f32 v95, v78, v79
    v_exp_f32 v18, v18
    v_exp_f32 v19, v19
    v_cvt_pk_bf16_f32 v80, v16, v17
    v_mfma_f32_32x32x16_bf16 v[112:127], v[160:163], v[92:95], v[112:127]
    s_waitcnt lgkmcnt(0)
    v_exp_f32 v20, v20
    v_exp_f32 v21, v21
    v_cvt_pk_bf16_f32 v81, v18, v19
    v_exp_f32 v22, v22
    v_mfma_f32_32x32x4_2b_bf16 v[48:79], v[146:147], v[136:137], 0 cbsz:1 abid:1
    v_exp_f32 v23, v23
    v_cvt_pk_bf16_f32 v82, v20, v21
    v_exp_f32 v24, v24
    v_exp_f32 v25, v25
    v_cvt_pk_bf16_f32 v83, v22, v23
    v_exp_f32 v26, v26
    v_exp_f32 v27, v27
    v_cvt_pk_bf16_f32 v84, v24, v25
    v_exp_f32 v28, v28
    v_exp_f32 v29, v29
    v_cvt_pk_bf16_f32 v85, v26, v27
    v_mfma_f32_32x32x16_bf16 v[96:111], v[148:151], v[80:83], v[96:111]
    ds_read_b128 v[156:159], v165 offset:20672
    v_exp_f32 v30, v30
    v_exp_f32 v31, v31
    v_cvt_pk_bf16_f32 v86, v28, v29
    v_exp_f32 v32, v32
    v_exp_f32 v33, v33
    v_cvt_pk_bf16_f32 v87, v30, v31
    v_mfma_f32_32x32x16_bf16 v[48:63], v[168:171], v[128:131], v[48:63]
    ds_read_b128 v[160:163], v165 offset:21280
    v_exp_f32 v34, v34
    v_exp_f32 v35, v35
    v_cvt_pk_bf16_f32 v88, v32, v33
    v_exp_f32 v36, v36
    v_exp_f32 v37, v37
    v_cvt_pk_bf16_f32 v89, v34, v35
    v_mfma_f32_32x32x16_bf16 v[96:111], v[152:155], v[84:87], v[96:111]
    ds_read_b128 v[140:143], v164 offset:21504
    v_exp_f32 v38, v38
    v_exp_f32 v39, v39
    v_cvt_pk_bf16_f32 v90, v36, v37
    v_exp_f32 v40, v40
    v_exp_f32 v41, v41
    v_cvt_pk_bf16_f32 v91, v38, v39
    v_exp_f32 v42, v42
    v_exp_f32 v43, v43
    v_cvt_pk_bf16_f32 v92, v40, v41
    v_mfma_f32_32x32x16_bf16 v[112:127], v[148:151], v[88:91], v[112:127]
    v_exp_f32 v44, v44
    v_exp_f32 v45, v45
    v_cvt_pk_bf16_f32 v93, v42, v43
    v_exp_f32 v46, v46
    v_mfma_f32_32x32x16_bf16 v[64:79], v[168:171], v[132:135], v[64:79]
    v_exp_f32 v47, v47
    v_cvt_pk_bf16_f32 v94, v44, v45
    v_exp_f32 v48, v48
    v_exp_f32 v49, v49
    v_cvt_pk_bf16_f32 v95, v46, v47
    v_exp_f32 v50, v50
    v_exp_f32 v51, v51
    v_cvt_pk_bf16_f32 v80, v48, v49
    v_mfma_f32_32x32x16_bf16 v[112:127], v[152:155], v[92:95], v[112:127]
    s_waitcnt lgkmcnt(0)
    v_exp_f32 v52, v52
    v_exp_f32 v53, v53
    v_cvt_pk_bf16_f32 v81, v50, v51
    v_exp_f32 v54, v54
    v_mfma_f32_32x32x4_2b_bf16 v[16:47], v[146:147], v[138:139], 0 cbsz:1 abid:0
    v_exp_f32 v55, v55
    v_cvt_pk_bf16_f32 v82, v52, v53
    v_exp_f32 v56, v56
    v_exp_f32 v57, v57
    v_cvt_pk_bf16_f32 v83, v54, v55
    v_exp_f32 v58, v58
    v_exp_f32 v59, v59
    v_cvt_pk_bf16_f32 v84, v56, v57
    v_exp_f32 v60, v60
    v_exp_f32 v61, v61
    v_cvt_pk_bf16_f32 v85, v58, v59
    v_mfma_f32_32x32x16_bf16 v[96:111], v[156:159], v[80:83], v[96:111]
    ds_read_b128 v[148:151], v165 offset:21888
    v_exp_f32 v62, v62
    v_exp_f32 v63, v63
    v_cvt_pk_bf16_f32 v86, v60, v61
    v_exp_f32 v64, v64
    v_exp_f32 v65, v65
    v_cvt_pk_bf16_f32 v87, v62, v63
    v_mfma_f32_32x32x16_bf16 v[16:31], v[140:143], v[128:131], v[16:31]
    ds_read_b128 v[152:155], v165 offset:22496
    v_exp_f32 v66, v66
    v_exp_f32 v67, v67
    v_cvt_pk_bf16_f32 v88, v64, v65
    v_exp_f32 v68, v68
    v_exp_f32 v69, v69
    v_cvt_pk_bf16_f32 v89, v66, v67
    v_mfma_f32_32x32x16_bf16 v[96:111], v[160:163], v[84:87], v[96:111]
    ds_read_b128 v[168:171], v164 offset:22528
    v_exp_f32 v70, v70
    v_exp_f32 v71, v71
    v_cvt_pk_bf16_f32 v90, v68, v69
    v_exp_f32 v72, v72
    v_exp_f32 v73, v73
    v_cvt_pk_bf16_f32 v91, v70, v71
    v_exp_f32 v74, v74
    v_exp_f32 v75, v75
    v_cvt_pk_bf16_f32 v92, v72, v73
    v_mfma_f32_32x32x16_bf16 v[112:127], v[156:159], v[88:91], v[112:127]
    ds_read_b64 v[144:145], v166 offset:38912
    v_exp_f32 v76, v76
    v_exp_f32 v77, v77
    v_cvt_pk_bf16_f32 v93, v74, v75
    v_exp_f32 v78, v78
    v_mfma_f32_32x32x16_bf16 v[32:47], v[140:143], v[132:135], v[32:47]
    v_exp_f32 v79, v79
    v_cvt_pk_bf16_f32 v94, v76, v77
    v_exp_f32 v16, v16
    v_exp_f32 v17, v17
    v_cvt_pk_bf16_f32 v95, v78, v79
    v_exp_f32 v18, v18
    v_exp_f32 v19, v19
    v_cvt_pk_bf16_f32 v80, v16, v17
    v_mfma_f32_32x32x16_bf16 v[112:127], v[160:163], v[92:95], v[112:127]
    s_waitcnt lgkmcnt(0)
    v_exp_f32 v20, v20
    v_exp_f32 v21, v21
    v_cvt_pk_bf16_f32 v81, v18, v19
    v_exp_f32 v22, v22
    v_mfma_f32_32x32x4_2b_bf16 v[48:79], v[146:147], v[138:139], 0 cbsz:1 abid:1
    v_exp_f32 v23, v23
    v_cvt_pk_bf16_f32 v82, v20, v21
    v_exp_f32 v24, v24
    v_exp_f32 v25, v25
    v_cvt_pk_bf16_f32 v83, v22, v23
    v_exp_f32 v26, v26
    v_exp_f32 v27, v27
    v_cvt_pk_bf16_f32 v84, v24, v25
    v_exp_f32 v28, v28
    v_exp_f32 v29, v29
    v_cvt_pk_bf16_f32 v85, v26, v27
    v_mfma_f32_32x32x16_bf16 v[96:111], v[148:151], v[80:83], v[96:111]
    ds_read_b128 v[156:159], v165 offset:23104
    v_exp_f32 v30, v30
    v_exp_f32 v31, v31
    v_cvt_pk_bf16_f32 v86, v28, v29
    v_exp_f32 v32, v32
    v_exp_f32 v33, v33
    v_cvt_pk_bf16_f32 v87, v30, v31
    v_mfma_f32_32x32x16_bf16 v[48:63], v[168:171], v[128:131], v[48:63]
    ds_read_b128 v[160:163], v165 offset:23712
    v_exp_f32 v34, v34
    v_exp_f32 v35, v35
    v_cvt_pk_bf16_f32 v88, v32, v33
    v_exp_f32 v36, v36
    v_exp_f32 v37, v37
    v_cvt_pk_bf16_f32 v89, v34, v35
    v_mfma_f32_32x32x16_bf16 v[96:111], v[152:155], v[84:87], v[96:111]
    ds_read_b128 v[140:143], v164 offset:38912
    v_exp_f32 v38, v38
    v_exp_f32 v39, v39
    v_cvt_pk_bf16_f32 v90, v36, v37
    v_exp_f32 v40, v40
    v_exp_f32 v41, v41
    v_cvt_pk_bf16_f32 v91, v38, v39
    v_exp_f32 v42, v42
    v_exp_f32 v43, v43
    v_cvt_pk_bf16_f32 v92, v40, v41
    v_mfma_f32_32x32x16_bf16 v[112:127], v[148:151], v[88:91], v[112:127]
    v_exp_f32 v44, v44
    v_exp_f32 v45, v45
    v_cvt_pk_bf16_f32 v93, v42, v43
    v_exp_f32 v46, v46
    v_mfma_f32_32x32x16_bf16 v[64:79], v[168:171], v[132:135], v[64:79]
    v_exp_f32 v47, v47
    v_cvt_pk_bf16_f32 v94, v44, v45
    v_exp_f32 v48, v48
    v_exp_f32 v49, v49
    v_cvt_pk_bf16_f32 v95, v46, v47
    v_exp_f32 v50, v50
    v_exp_f32 v51, v51
    v_cvt_pk_bf16_f32 v80, v48, v49
    v_mfma_f32_32x32x16_bf16 v[112:127], v[152:155], v[92:95], v[112:127]
    s_waitcnt lgkmcnt(0)
    v_exp_f32 v52, v52
    v_exp_f32 v53, v53
    v_cvt_pk_bf16_f32 v81, v50, v51
    v_exp_f32 v54, v54
    v_mfma_f32_32x32x4_2b_bf16 v[16:47], v[144:145], v[136:137], 0 cbsz:1 abid:0
    v_exp_f32 v55, v55
    v_cvt_pk_bf16_f32 v82, v52, v53
    v_exp_f32 v56, v56
    v_exp_f32 v57, v57
    v_cvt_pk_bf16_f32 v83, v54, v55
    v_exp_f32 v58, v58
    v_exp_f32 v59, v59
    v_cvt_pk_bf16_f32 v84, v56, v57
    v_exp_f32 v60, v60
    v_exp_f32 v61, v61
    v_cvt_pk_bf16_f32 v85, v58, v59
    v_mfma_f32_32x32x16_bf16 v[96:111], v[156:159], v[80:83], v[96:111]
    ds_read_b128 v[148:151], v165 offset:38912
    v_exp_f32 v62, v62
    v_exp_f32 v63, v63
    v_cvt_pk_bf16_f32 v86, v60, v61
    v_exp_f32 v64, v64
    v_exp_f32 v65, v65
    v_cvt_pk_bf16_f32 v87, v62, v63
    v_mfma_f32_32x32x16_bf16 v[16:31], v[140:143], v[128:131], v[16:31]
    ds_read_b128 v[152:155], v165 offset:39520
    v_exp_f32 v66, v66
    v_exp_f32 v67, v67
    v_cvt_pk_bf16_f32 v88, v64, v65
    v_exp_f32 v68, v68
    v_exp_f32 v69, v69
    v_cvt_pk_bf16_f32 v89, v66, v67
    v_mfma_f32_32x32x16_bf16 v[96:111], v[160:163], v[84:87], v[96:111]
    ds_read_b128 v[168:171], v164 offset:39936
    v_exp_f32 v70, v70
    v_exp_f32 v71, v71
    v_cvt_pk_bf16_f32 v90, v68, v69
    v_exp_f32 v72, v72
    v_exp_f32 v73, v73
    v_cvt_pk_bf16_f32 v91, v70, v71
    v_exp_f32 v74, v74
    v_exp_f32 v75, v75
    v_cvt_pk_bf16_f32 v92, v72, v73
    v_mfma_f32_32x32x16_bf16 v[112:127], v[156:159], v[88:91], v[112:127]
    v_exp_f32 v76, v76
    v_exp_f32 v77, v77
    v_cvt_pk_bf16_f32 v93, v74, v75
    v_exp_f32 v78, v78
    v_mfma_f32_32x32x16_bf16 v[32:47], v[140:143], v[132:135], v[32:47]
    v_exp_f32 v79, v79
    v_cvt_pk_bf16_f32 v94, v76, v77
    v_add_u32 v164, 38912, v164
    v_add_u32 v165, 38912, v165
    v_add_u32 v166, 38912, v166
    v_exp_f32 v16, v16
    v_exp_f32 v17, v17
    v_cvt_pk_bf16_f32 v95, v78, v79
    v_exp_f32 v18, v18
    v_exp_f32 v19, v19
    v_cvt_pk_bf16_f32 v80, v16, v17
    v_mfma_f32_32x32x16_bf16 v[112:127], v[160:163], v[92:95], v[112:127]
    s_waitcnt lgkmcnt(0)
    v_exp_f32 v20, v20
    v_exp_f32 v21, v21
    v_cvt_pk_bf16_f32 v81, v18, v19
    v_exp_f32 v22, v22
    v_mfma_f32_32x32x4_2b_bf16 v[48:79], v[144:145], v[136:137], 0 cbsz:1 abid:1
    v_exp_f32 v23, v23
    v_cvt_pk_bf16_f32 v82, v20, v21
    v_exp_f32 v24, v24
    v_exp_f32 v25, v25
    v_cvt_pk_bf16_f32 v83, v22, v23
    v_exp_f32 v26, v26
    v_exp_f32 v27, v27
    v_cvt_pk_bf16_f32 v84, v24, v25
    v_exp_f32 v28, v28
    v_exp_f32 v29, v29
    v_cvt_pk_bf16_f32 v85, v26, v27
    v_mfma_f32_32x32x16_bf16 v[96:111], v[148:151], v[80:83], v[96:111]
    ds_read_b128 v[156:159], v165 offset:1216
    v_exp_f32 v30, v30
    v_exp_f32 v31, v31
    v_cvt_pk_bf16_f32 v86, v28, v29
    v_exp_f32 v32, v32
    v_exp_f32 v33, v33
    v_cvt_pk_bf16_f32 v87, v30, v31
    v_mfma_f32_32x32x16_bf16 v[48:63], v[168:171], v[128:131], v[48:63]
    ds_read_b128 v[160:163], v165 offset:1824
    v_exp_f32 v34, v34
    v_exp_f32 v35, v35
    v_cvt_pk_bf16_f32 v88, v32, v33
    v_exp_f32 v36, v36
    v_exp_f32 v37, v37
    v_cvt_pk_bf16_f32 v89, v34, v35
    v_mfma_f32_32x32x16_bf16 v[96:111], v[152:155], v[84:87], v[96:111]
    ds_read_b128 v[140:143], v164 offset:2048
    v_exp_f32 v38, v38
    v_exp_f32 v39, v39
    v_cvt_pk_bf16_f32 v90, v36, v37
    v_exp_f32 v40, v40
    v_exp_f32 v41, v41
    v_cvt_pk_bf16_f32 v91, v38, v39
    v_exp_f32 v42, v42
    v_exp_f32 v43, v43
    v_cvt_pk_bf16_f32 v92, v40, v41
    v_mfma_f32_32x32x16_bf16 v[112:127], v[148:151], v[88:91], v[112:127]
    v_exp_f32 v44, v44
    v_exp_f32 v45, v45
    v_cvt_pk_bf16_f32 v93, v42, v43
    v_exp_f32 v46, v46
    v_mfma_f32_32x32x16_bf16 v[64:79], v[168:171], v[132:135], v[64:79]
    v_exp_f32 v47, v47
    v_cvt_pk_bf16_f32 v94, v44, v45
    v_exp_f32 v48, v48
    v_exp_f32 v49, v49
    v_cvt_pk_bf16_f32 v95, v46, v47
    v_exp_f32 v50, v50
    v_exp_f32 v51, v51
    v_cvt_pk_bf16_f32 v80, v48, v49
    v_mfma_f32_32x32x16_bf16 v[112:127], v[152:155], v[92:95], v[112:127]
    s_waitcnt lgkmcnt(0)
    v_exp_f32 v52, v52
    v_exp_f32 v53, v53
    v_cvt_pk_bf16_f32 v81, v50, v51
    v_exp_f32 v54, v54
    v_mfma_f32_32x32x4_2b_bf16 v[16:47], v[144:145], v[138:139], 0 cbsz:1 abid:0
    v_exp_f32 v55, v55
    v_cvt_pk_bf16_f32 v82, v52, v53
    v_exp_f32 v56, v56
    v_exp_f32 v57, v57
    v_cvt_pk_bf16_f32 v83, v54, v55
    v_exp_f32 v58, v58
    v_exp_f32 v59, v59
    v_cvt_pk_bf16_f32 v84, v56, v57
    v_exp_f32 v60, v60
    v_exp_f32 v61, v61
    v_cvt_pk_bf16_f32 v85, v58, v59
    v_mfma_f32_32x32x16_bf16 v[96:111], v[156:159], v[80:83], v[96:111]
    ds_read_b128 v[148:151], v165 offset:2432
    v_exp_f32 v62, v62
    v_exp_f32 v63, v63
    v_cvt_pk_bf16_f32 v86, v60, v61
    v_exp_f32 v64, v64
    v_exp_f32 v65, v65
    v_cvt_pk_bf16_f32 v87, v62, v63
    v_mfma_f32_32x32x16_bf16 v[16:31], v[140:143], v[128:131], v[16:31]
    ds_read_b128 v[152:155], v165 offset:3040
    v_exp_f32 v66, v66
    v_exp_f32 v67, v67
    v_cvt_pk_bf16_f32 v88, v64, v65
    v_exp_f32 v68, v68
    v_exp_f32 v69, v69
    v_cvt_pk_bf16_f32 v89, v66, v67
    v_mfma_f32_32x32x16_bf16 v[96:111], v[160:163], v[84:87], v[96:111]
    ds_read_b128 v[168:171], v164 offset:3072
    v_exp_f32 v70, v70
    v_exp_f32 v71, v71
    v_cvt_pk_bf16_f32 v90, v68, v69
    v_exp_f32 v72, v72
    v_exp_f32 v73, v73
    v_cvt_pk_bf16_f32 v91, v70, v71
    v_exp_f32 v74, v74
    v_exp_f32 v75, v75
    v_cvt_pk_bf16_f32 v92, v72, v73
    v_mfma_f32_32x32x16_bf16 v[112:127], v[156:159], v[88:91], v[112:127]
    ds_read_b64 v[146:147], v166 offset:19456
    v_exp_f32 v76, v76
    v_exp_f32 v77, v77
    v_cvt_pk_bf16_f32 v93, v74, v75
    v_exp_f32 v78, v78
    v_mfma_f32_32x32x16_bf16 v[32:47], v[140:143], v[132:135], v[32:47]
    v_exp_f32 v79, v79
    v_cvt_pk_bf16_f32 v94, v76, v77
    s_setprio 0
    v_exp_f32 v16, v16
    v_exp_f32 v17, v17
    v_cvt_pk_bf16_f32 v95, v78, v79
    v_exp_f32 v18, v18
    v_exp_f32 v19, v19
    v_cvt_pk_bf16_f32 v80, v16, v17
    v_mfma_f32_32x32x16_bf16 v[112:127], v[160:163], v[92:95], v[112:127]
    s_waitcnt lgkmcnt(0)
    v_exp_f32 v20, v20
    v_exp_f32 v21, v21
    v_cvt_pk_bf16_f32 v81, v18, v19
    v_exp_f32 v22, v22
    v_mfma_f32_32x32x4_2b_bf16 v[48:79], v[144:145], v[138:139], 0 cbsz:1 abid:1
    v_exp_f32 v23, v23
    v_cvt_pk_bf16_f32 v82, v20, v21
    v_exp_f32 v24, v24
    v_exp_f32 v25, v25
    v_cvt_pk_bf16_f32 v83, v22, v23
    v_exp_f32 v26, v26
    v_exp_f32 v27, v27
    v_cvt_pk_bf16_f32 v84, v24, v25
    v_exp_f32 v28, v28
    v_exp_f32 v29, v29
    v_cvt_pk_bf16_f32 v85, v26, v27
    v_mfma_f32_32x32x16_bf16 v[96:111], v[148:151], v[80:83], v[96:111]
    ds_read_b128 v[156:159], v165 offset:3648
    v_exp_f32 v30, v30
    v_exp_f32 v31, v31
    v_cvt_pk_bf16_f32 v86, v28, v29
    v_exp_f32 v32, v32
    v_exp_f32 v33, v33
    v_cvt_pk_bf16_f32 v87, v30, v31
    v_mfma_f32_32x32x16_bf16 v[48:63], v[168:171], v[128:131], v[48:63]
    ds_read_b128 v[160:163], v165 offset:4256
    v_exp_f32 v34, v34
    v_exp_f32 v35, v35
    v_cvt_pk_bf16_f32 v88, v32, v33
    v_exp_f32 v36, v36
    v_exp_f32 v37, v37
    v_cvt_pk_bf16_f32 v89, v34, v35
    v_mfma_f32_32x32x16_bf16 v[96:111], v[152:155], v[84:87], v[96:111]
    ds_read_b128 v[140:143], v164 offset:19456
    v_exp_f32 v38, v38
    v_exp_f32 v39, v39
    v_cvt_pk_bf16_f32 v90, v36, v37
    v_exp_f32 v40, v40
    v_exp_f32 v41, v41
    v_cvt_pk_bf16_f32 v91, v38, v39
    v_exp_f32 v42, v42
    v_exp_f32 v43, v43
    v_cvt_pk_bf16_f32 v92, v40, v41
    v_mfma_f32_32x32x16_bf16 v[112:127], v[148:151], v[88:91], v[112:127]
    v_exp_f32 v44, v44
    v_exp_f32 v45, v45
    v_cvt_pk_bf16_f32 v93, v42, v43
    v_exp_f32 v46, v46
    v_mfma_f32_32x32x16_bf16 v[64:79], v[168:171], v[132:135], v[64:79]
    v_exp_f32 v47, v47
    v_cvt_pk_bf16_f32 v94, v44, v45
    v_exp_f32 v48, v48
    v_exp_f32 v49, v49
    v_cvt_pk_bf16_f32 v95, v46, v47
    v_exp_f32 v50, v50
    v_exp_f32 v51, v51
    v_cvt_pk_bf16_f32 v80, v48, v49
    v_mfma_f32_32x32x16_bf16 v[112:127], v[152:155], v[92:95], v[112:127]
    s_waitcnt lgkmcnt(0)
    v_exp_f32 v52, v52
    v_exp_f32 v53, v53
    v_cvt_pk_bf16_f32 v81, v50, v51
    v_exp_f32 v54, v54
    v_mfma_f32_32x32x4_2b_bf16 v[16:47], v[146:147], v[136:137], 0 cbsz:1 abid:0
    v_exp_f32 v55, v55
    v_cvt_pk_bf16_f32 v82, v52, v53
    v_exp_f32 v56, v56
    v_exp_f32 v57, v57
    v_cvt_pk_bf16_f32 v83, v54, v55
    v_exp_f32 v58, v58
    v_exp_f32 v59, v59
    v_cvt_pk_bf16_f32 v84, v56, v57
    v_exp_f32 v60, v60
    v_exp_f32 v61, v61
    v_cvt_pk_bf16_f32 v85, v58, v59
    v_mfma_f32_32x32x16_bf16 v[96:111], v[156:159], v[80:83], v[96:111]
    ds_read_b128 v[148:151], v165 offset:19456
    v_exp_f32 v62, v62
    v_exp_f32 v63, v63
    v_cvt_pk_bf16_f32 v86, v60, v61
    v_exp_f32 v64, v64
    v_exp_f32 v65, v65
    v_cvt_pk_bf16_f32 v87, v62, v63
    v_mfma_f32_32x32x16_bf16 v[16:31], v[140:143], v[128:131], v[16:31]
    ds_read_b128 v[152:155], v165 offset:20064
    v_exp_f32 v66, v66
    v_exp_f32 v67, v67
    v_cvt_pk_bf16_f32 v88, v64, v65
    v_exp_f32 v68, v68
    v_exp_f32 v69, v69
    v_cvt_pk_bf16_f32 v89, v66, v67
    v_mfma_f32_32x32x16_bf16 v[96:111], v[160:163], v[84:87], v[96:111]
    ds_read_b128 v[168:171], v164 offset:20480
    v_exp_f32 v70, v70
    v_exp_f32 v71, v71
    v_cvt_pk_bf16_f32 v90, v68, v69
    v_exp_f32 v72, v72
    v_exp_f32 v73, v73
    v_cvt_pk_bf16_f32 v91, v70, v71
    v_exp_f32 v74, v74
    v_exp_f32 v75, v75
    v_cvt_pk_bf16_f32 v92, v72, v73
    v_mfma_f32_32x32x16_bf16 v[112:127], v[156:159], v[88:91], v[112:127]
    v_exp_f32 v76, v76
    v_exp_f32 v77, v77
    v_cvt_pk_bf16_f32 v93, v74, v75
    v_exp_f32 v78, v78
    v_mfma_f32_32x32x16_bf16 v[32:47], v[140:143], v[132:135], v[32:47]
    v_exp_f32 v79, v79
    v_cvt_pk_bf16_f32 v94, v76, v77
    v_exp_f32 v16, v16
    v_exp_f32 v17, v17
    v_cvt_pk_bf16_f32 v95, v78, v79
    v_exp_f32 v18, v18
    v_exp_f32 v19, v19
    v_cvt_pk_bf16_f32 v80, v16, v17
    v_mfma_f32_32x32x16_bf16 v[112:127], v[160:163], v[92:95], v[112:127]
    s_waitcnt lgkmcnt(0)
    v_exp_f32 v20, v20
    v_exp_f32 v21, v21
    v_cvt_pk_bf16_f32 v81, v18, v19
    v_exp_f32 v22, v22
    v_mfma_f32_32x32x4_2b_bf16 v[48:79], v[146:147], v[136:137], 0 cbsz:1 abid:1
    v_exp_f32 v23, v23
    v_cvt_pk_bf16_f32 v82, v20, v21
    v_exp_f32 v24, v24
    v_exp_f32 v25, v25
    v_cvt_pk_bf16_f32 v83, v22, v23
    v_exp_f32 v26, v26
    v_exp_f32 v27, v27
    v_cvt_pk_bf16_f32 v84, v24, v25
    v_exp_f32 v28, v28
    v_exp_f32 v29, v29
    v_cvt_pk_bf16_f32 v85, v26, v27
    v_mfma_f32_32x32x16_bf16 v[96:111], v[148:151], v[80:83], v[96:111]
    ds_read_b128 v[156:159], v165 offset:20672
    v_exp_f32 v30, v30
    v_exp_f32 v31, v31
    v_cvt_pk_bf16_f32 v86, v28, v29
    v_exp_f32 v32, v32
    v_exp_f32 v33, v33
    v_cvt_pk_bf16_f32 v87, v30, v31
    v_mfma_f32_32x32x16_bf16 v[48:63], v[168:171], v[128:131], v[48:63]
    ds_read_b128 v[160:163], v165 offset:21280
    v_exp_f32 v34, v34
    v_exp_f32 v35, v35
    v_cvt_pk_bf16_f32 v88, v32, v33
    v_exp_f32 v36, v36
    v_exp_f32 v37, v37
    v_cvt_pk_bf16_f32 v89, v34, v35
    v_mfma_f32_32x32x16_bf16 v[96:111], v[152:155], v[84:87], v[96:111]
    ds_read_b128 v[140:143], v164 offset:21504
    v_exp_f32 v38, v38
    v_exp_f32 v39, v39
    v_cvt_pk_bf16_f32 v90, v36, v37
    v_exp_f32 v40, v40
    v_exp_f32 v41, v41
    v_cvt_pk_bf16_f32 v91, v38, v39
    v_exp_f32 v42, v42
    v_exp_f32 v43, v43
    v_cvt_pk_bf16_f32 v92, v40, v41
    v_mfma_f32_32x32x16_bf16 v[112:127], v[148:151], v[88:91], v[112:127]
    v_exp_f32 v44, v44
    v_exp_f32 v45, v45
    v_cvt_pk_bf16_f32 v93, v42, v43
    v_exp_f32 v46, v46
    v_mfma_f32_32x32x16_bf16 v[64:79], v[168:171], v[132:135], v[64:79]
    v_exp_f32 v47, v47
    v_cvt_pk_bf16_f32 v94, v44, v45
    s_mul_i32 s58, s3, 8064
    s_mul_i32 s35, s5, 144
    s_add_u32 s58, s58, s35
    s_mul_i32 s59, s3, 1008
    s_waitcnt vmcnt(0)
    s_barrier
    s_cmp_eq_u32 s7, 0
    s_cbranch_scc1 L_pr21
    s_setprio 1
L_pr21:
    v_exp_f32 v48, v48
    v_exp_f32 v49, v49
    v_cvt_pk_bf16_f32 v95, v46, v47
    v_exp_f32 v50, v50
    v_exp_f32 v51, v51
    v_cvt_pk_bf16_f32 v80, v48, v49
    v_mfma_f32_32x32x16_bf16 v[112:127], v[152:155], v[92:95], v[112:127]
    s_waitcnt lgkmcnt(0)
    v_exp_f32 v52, v52
    v_exp_f32 v53, v53
    v_cvt_pk_bf16_f32 v81, v50, v51
    v_exp_f32 v54, v54
    v_mfma_f32_32x32x4_2b_bf16 v[16:47], v[146:147], v[138:139], 0 cbsz:1 abid:0
    s_lshl_b32 s57, s4, 10
    s_add_u32 s57, s57, 212992
    s_cmp_lg_u32 s3, 0
    s_cbranch_scc1 L_nsf
    s_lshl_b32 s35, s5, 7
    s_add_u32 s34, s57, s35
    s_mov_b64 exec, 1
    buffer_store_dwordx2 v[172:173], v5, s[28:31], s34 offen sc1
    s_mov_b64 exec, -1
L_nsf:
    v_and_b32 v180, 7, v1
    v_lshlrev_b32 v180, 7, v180
    v_exp_f32 v55, v55
    v_cvt_pk_bf16_f32 v82, v52, v53
    v_exp_f32 v56, v56
    v_exp_f32 v57, v57
    v_cvt_pk_bf16_f32 v83, v54, v55
    v_exp_f32 v58, v58
    v_exp_f32 v59, v59
    v_cvt_pk_bf16_f32 v84, v56, v57
    v_exp_f32 v60, v60
    v_exp_f32 v61, v61
    v_cvt_pk_bf16_f32 v85, v58, v59
    v_mfma_f32_32x32x16_bf16 v[96:111], v[156:159], v[80:83], v[96:111]
    ds_read_b128 v[148:151], v165 offset:21888
    v_exp_f32 v62, v62
    v_exp_f32 v63, v63
    v_cvt_pk_bf16_f32 v86, v60, v61
    s_add_u32 m0, s59, 0
    s_add_u32 s58, s58, 0
    buffer_load_dwordx4 v3, s[20:23], s58 offen lds
    v_exp_f32 v64, v64
    v_exp_f32 v65, v65
    v_cvt_pk_bf16_f32 v87, v62, v63
    v_mfma_f32_32x32x16_bf16 v[16:31], v[140:143], v[128:131], v[16:31]
    ds_read_b128 v[152:155], v165 offset:22496
    v_exp_f32 v66, v66
    v_exp_f32 v67, v67
    v_cvt_pk_bf16_f32 v88, v64, v65
    v_exp_f32 v68, v68
    v_exp_f32 v69, v69
    v_cvt_pk_bf16_f32 v89, v66, v67
    v_mfma_f32_32x32x16_bf16 v[96:111], v[160:163], v[84:87], v[96:111]
    ds_read_b128 v[168:171], v164 offset:22528
    v_exp_f32 v70, v70
    v_exp_f32 v71, v71
    v_cvt_pk_bf16_f32 v90, v68, v69
    v_exp_f32 v72, v72
    v_exp_f32 v73, v73
    v_cvt_pk_bf16_f32 v91, v70, v71
    s_add_u32 m0, s59, 8064
    s_add_u32 s58, s58, 64512
    buffer_load_dwordx4 v3, s[20:23], s58 offen lds
    v_exp_f32 v74, v74
    v_exp_f32 v75, v75
    v_cvt_pk_bf16_f32 v92, v72, v73
    v_mfma_f32_32x32x16_bf16 v[112:127], v[156:159], v[88:91], v[112:127]
    ds_read_b64 v[144:145], v166 offset:38912
    v_exp_f32 v76, v76
    v_exp_f32 v77, v77
    v_cvt_pk_bf16_f32 v93, v74, v75
    v_exp_f32 v78, v78
    v_mfma_f32_32x32x16_bf16 v[32:47], v[140:143], v[132:135], v[32:47]
    v_exp_f32 v79, v79
    v_cvt_pk_bf16_f32 v94, v76, v77
    v_exp_f32 v16, v16
    v_exp_f32 v17, v17
    v_cvt_pk_bf16_f32 v95, v78, v79
    v_exp_f32 v18, v18
    v_exp_f32 v19, v19
    v_cvt_pk_bf16_f32 v80, v16, v17
    v_mfma_f32_32x32x16_bf16 v[112:127], v[160:163], v[92:95], v[112:127]
    s_waitcnt lgkmcnt(0)
    v_exp_f32 v20, v20
    v_exp_f32 v21, v21
    v_cvt_pk_bf16_f32 v81, v18, v19
    v_exp_f32 v22, v22
    v_mfma_f32_32x32x4_2b_bf16 v[48:79], v[146:147], v[138:139], 0 cbsz:1 abid:1
    v_exp_f32 v23, v23
    v_cvt_pk_bf16_f32 v82, v20, v21
    v_exp_f32 v24, v24
    v_exp_f32 v25, v25
    v_cvt_pk_bf16_f32 v83, v22, v23
    v_exp_f32 v26, v26
    v_exp_f32 v27, v27
    v_cvt_pk_bf16_f32 v84, v24, v25
    v_exp_f32 v28, v28
    v_exp_f32 v29, v29
    v_cvt_pk_bf16_f32 v85, v26, v27
    v_mfma_f32_32x32x16_bf16 v[96:111], v[148:151], v[80:83], v[96:111]
    ds_read_b128 v[156:159], v165 offset:23104
    v_exp_f32 v30, v30
    v_exp_f32 v31, v31
    v_cvt_pk_bf16_f32 v86, v28, v29
    v_exp_f32 v32, v32
    v_exp_f32 v33, v33
    v_cvt_pk_bf16_f32 v87, v30, v31
    v_mfma_f32_32x32x16_bf16 v[48:63], v[168:171], v[128:131], v[48:63]
    ds_read_b128 v[160:163], v165 offset:23712
    v_exp_f32 v34, v34
    v_exp_f32 v35, v35
    v_cvt_pk_bf16_f32 v88, v32, v33
    s_add_u32 m0, s59, 16128
    s_add_u32 s58, s58, 64512
    buffer_load_dwordx4 v3, s[20:23], s58 offen lds
    v_exp_f32 v36, v36
    v_exp_f32 v37, v37
    v_cvt_pk_bf16_f32 v89, v34, v35
    v_mfma_f32_32x32x16_bf16 v[96:111], v[152:155], v[84:87], v[96:111]
    ds_read_b128 v[140:143], v164 offset:38912
    v_exp_f32 v38, v38
    v_exp_f32 v39, v39
    v_cvt_pk_bf16_f32 v90, v36, v37
    v_exp_f32 v40, v40
    v_exp_f32 v41, v41
    v_cvt_pk_bf16_f32 v91, v38, v39
    v_exp_f32 v42, v42
    v_exp_f32 v43, v43
    v_cvt_pk_bf16_f32 v92, v40, v41
    v_mfma_f32_32x32x16_bf16 v[112:127], v[148:151], v[88:91], v[112:127]
    v_exp_f32 v44, v44
    v_exp_f32 v45, v45
    v_cvt_pk_bf16_f32 v93, v42, v43
    v_exp_f32 v46, v46
    v_mfma_f32_32x32x16_bf16 v[64:79], v[168:171], v[132:135], v[64:79]
    v_exp_f32 v47, v47
    v_cvt_pk_bf16_f32 v94, v44, v45
    v_exp_f32 v48, v48
    v_exp_f32 v49, v49
    v_cvt_pk_bf16_f32 v95, v46, v47
    v_exp_f32 v50, v50
    v_exp_f32 v51, v51
    v_cvt_pk_bf16_f32 v80, v48, v49
    v_mfma_f32_32x32x16_bf16 v[112:127], v[152:155], v[92:95], v[112:127]
    s_waitcnt lgkmcnt(0)
    v_exp_f32 v52, v52
    v_exp_f32 v53, v53
    v_cvt_pk_bf16_f32 v81, v50, v51
    v_exp_f32 v54, v54
    v_mfma_f32_32x32x4_2b_bf16 v[16:47], v[144:145], v[136:137], 0 cbsz:1 abid:0
    v_exp_f32 v55, v55
    v_cvt_pk_bf16_f32 v82, v52, v53
    v_exp_f32 v56, v56
    v_exp_f32 v57, v57
    v_cvt_pk_bf16_f32 v83, v54, v55
    v_exp_f32 v58, v58
    v_exp_f32 v59, v59
    v_cvt_pk_bf16_f32 v84, v56, v57
    v_exp_f32 v60, v60
    v_exp_f32 v61, v61
    v_cvt_pk_bf16_f32 v85, v58, v59
    v_mfma_f32_32x32x16_bf16 v[96:111], v[156:159], v[80:83], v[96:111]
    ds_read_b128 v[148:151], v165 offset:38912
    v_exp_f32 v62, v62
    v_exp_f32 v63, v63
    v_cvt_pk_bf16_f32 v86, v60, v61
    s_add_u32 m0, s59, 24192
    s_add_u32 s58, s58, 64512
    buffer_load_dwordx4 v3, s[20:23], s58 offen lds
    v_exp_f32 v64, v64
    v_exp_f32 v65, v65
    v_cvt_pk_bf16_f32 v87, v62, v63
    v_mfma_f32_32x32x16_bf16 v[16:31], v[140:143], v[128:131], v[16:31]
    ds_read_b128 v[152:155], v165 offset:39520
    v_exp_f32 v66, v66
    v_exp_f32 v67, v67
    v_cvt_pk_bf16_f32 v88, v64, v65
    v_exp_f32 v68, v68
    v_exp_f32 v69, v69
    v_cvt_pk_bf16_f32 v89, v66, v67
    v_mfma_f32_32x32x16_bf16 v[96:111], v[160:163], v[84:87], v[96:111]
    ds_read_b128 v[168:171], v164 offset:39936
    v_exp_f32 v70, v70
    v_exp_f32 v71, v71
    v_cvt_pk_bf16_f32 v90, v68, v69
    v_exp_f32 v72, v72
    v_exp_f32 v73, v73
    v_cvt_pk_bf16_f32 v91, v70, v71
    s_add_u32 m0, s59, 32256
    s_add_u32 s58, s58, 64512
    buffer_load_dwordx4 v3, s[20:23], s58 offen lds
    v_exp_f32 v74, v74
    v_exp_f32 v75, v75
    v_cvt_pk_bf16_f32 v92, v72, v73
    v_mfma_f32_32x32x16_bf16 v[112:127], v[156:159], v[88:91], v[112:127]
    v_exp_f32 v76, v76
    v_exp_f32 v77, v77
    v_cvt_pk_bf16_f32 v93, v74, v75
    v_exp_f32 v78, v78
    v_mfma_f32_32x32x16_bf16 v[32:47], v[140:143], v[132:135], v[32:47]
    v_exp_f32 v79, v79
    v_cvt_pk_bf16_f32 v94, v76, v77
    v_add_u32 v164, 38912, v164
    v_add_u32 v165, 38912, v165
    v_add_u32 v166, 38912, v166
    v_exp_f32 v16, v16
    v_exp_f32 v17, v17
    v_cvt_pk_bf16_f32 v95, v78, v79
    v_exp_f32 v18, v18
    v_exp_f32 v19, v19
    v_cvt_pk_bf16_f32 v80, v16, v17
    v_mfma_f32_32x32x16_bf16 v[112:127], v[160:163], v[92:95], v[112:127]
    s_waitcnt lgkmcnt(0)
    v_exp_f32 v20, v20
    v_exp_f32 v21, v21
    v_cvt_pk_bf16_f32 v81, v18, v19
    v_exp_f32 v22, v22
    v_mfma_f32_32x32x4_2b_bf16 v[48:79], v[144:145], v[136:137], 0 cbsz:1 abid:1
    v_exp_f32 v23, v23
    v_cvt_pk_bf16_f32 v82, v20, v21
    v_exp_f32 v24, v24
    v_exp_f32 v25, v25
    v_cvt_pk_bf16_f32 v83, v22, v23
    v_exp_f32 v26, v26
    v_exp_f32 v27, v27
    v_cvt_pk_bf16_f32 v84, v24, v25
    v_exp_f32 v28, v28
    v_exp_f32 v29, v29
    v_cvt_pk_bf16_f32 v85, v26, v27
    v_mfma_f32_32x32x16_bf16 v[96:111], v[148:151], v[80:83], v[96:111]
    ds_read_b128 v[156:159], v165 offset:1216
    v_exp_f32 v30, v30
    v_exp_f32 v31, v31
    v_cvt_pk_bf16_f32 v86, v28, v29
    v_exp_f32 v32, v32
    v_exp_f32 v33, v33
    v_cvt_pk_bf16_f32 v87, v30, v31
    v_mfma_f32_32x32x16_bf16 v[48:63], v[168:171], v[128:131], v[48:63]
    ds_read_b128 v[160:163], v165 offset:1824
    v_exp_f32 v34, v34
    v_exp_f32 v35, v35
    v_cvt_pk_bf16_f32 v88, v32, v33
    s_add_u32 m0, s59, 40320
    s_add_u32 s58, s58, 64512
    buffer_load_dwordx4 v3, s[20:23], s58 offen lds
    v_exp_f32 v36, v36
    v_exp_f32 v37, v37
    v_cvt_pk_bf16_f32 v89, v34, v35
    v_mfma_f32_32x32x16_bf16 v[96:111], v[152:155], v[84:87], v[96:111]
    ds_read_b128 v[140:143], v164 offset:2048
    v_exp_f32 v38, v38
    v_exp_f32 v39, v39
    v_cvt_pk_bf16_f32 v90, v36, v37
    v_exp_f32 v40, v40
    v_exp_f32 v41, v41
    v_cvt_pk_bf16_f32 v91, v38, v39
    v_exp_f32 v42, v42
    v_exp_f32 v43, v43
    v_cvt_pk_bf16_f32 v92, v40, v41
    v_mfma_f32_32x32x16_bf16 v[112:127], v[148:151], v[88:91], v[112:127]
    v_exp_f32 v44, v44
    v_exp_f32 v45, v45
    v_cvt_pk_bf16_f32 v93, v42, v43
    v_exp_f32 v46, v46
    v_mfma_f32_32x32x16_bf16 v[64:79], v[168:171], v[132:135], v[64:79]
    v_exp_f32 v47, v47
    v_cvt_pk_bf16_f32 v94, v44, v45
    v_exp_f32 v48, v48
    v_exp_f32 v49, v49
    v_cvt_pk_bf16_f32 v95, v46, v47
    v_exp_f32 v50, v50
    v_exp_f32 v51, v51
    v_cvt_pk_bf16_f32 v80, v48, v49
    v_mfma_f32_32x32x16_bf16 v[112:127], v[152:155], v[92:95], v[112:127]
    s_waitcnt lgkmcnt(0)
    v_exp_f32 v52, v52
    v_exp_f32 v53, v53
    v_cvt_pk_bf16_f32 v81, v50, v51
    v_exp_f32 v54, v54
    v_mfma_f32_32x32x4_2b_bf16 v[16:47], v[144:145], v[138:139], 0 cbsz:1 abid:0
    v_exp_f32 v55, v55
    v_cvt_pk_bf16_f32 v82, v52, v53
    v_exp_f32 v56, v56
    v_exp_f32 v57, v57
    v_cvt_pk_bf16_f32 v83, v54, v55
    v_exp_f32 v58, v58
    v_exp_f32 v59, v59
    v_cvt_pk_bf16_f32 v84, v56, v57
    v_exp_f32 v60, v60
    v_exp_f32 v61, v61
    v_cvt_pk_bf16_f32 v85, v58, v59
    v_mfma_f32_32x32x16_bf16 v[96:111], v[156:159], v[80:83], v[96:111]
    ds_read_b128 v[148:151], v165 offset:2432
    v_exp_f32 v62, v62
    v_exp_f32 v63, v63
    v_cvt_pk_bf16_f32 v86, v60, v61
    s_add_u32 m0, s59, 48384
    s_add_u32 s58, s58, 64512
    buffer_load_dwordx4 v3, s[20:23], s58 offen lds
    v_exp_f32 v64, v64
    v_exp_f32 v65, v65
    v_cvt_pk_bf16_f32 v87, v62, v63
    v_mfma_f32_32x32x16_bf16 v[16:31], v[140:143], v[128:131], v[16:31]
    ds_read_b128 v[152:155], v165 offset:3040
    v_exp_f32 v66, v66
    v_exp_f32 v67, v67
    v_cvt_pk_bf16_f32 v88, v64, v65
    v_exp_f32 v68, v68
    v_exp_f32 v69, v69
    v_cvt_pk_bf16_f32 v89, v66, v67
    v_mfma_f32_32x32x16_bf16 v[96:111], v[160:163], v[84:87], v[96:111]
    ds_read_b128 v[168:171], v164 offset:3072
    v_exp_f32 v70, v70
    v_exp_f32 v71, v71
    v_cvt_pk_bf16_f32 v90, v68, v69
    v_exp_f32 v72, v72
    v_exp_f32 v73, v73
    v_cvt_pk_bf16_f32 v91, v70, v71
    s_add_u32 m0, s59, 56448
    s_add_u32 s58, s58, 64512
    buffer_load_dwordx4 v3, s[20:23], s58 offen lds
    v_exp_f32 v74, v74
    v_exp_f32 v75, v75
    v_cvt_pk_bf16_f32 v92, v72, v73
    v_mfma_f32_32x32x16_bf16 v[112:127], v[156:159], v[88:91], v[112:127]
    ds_read_b64 v[146:147], v166 offset:19456
    v_exp_f32 v76, v76
    v_exp_f32 v77, v77
    v_cvt_pk_bf16_f32 v93, v74, v75
    v_exp_f32 v78, v78
    v_mfma_f32_32x32x16_bf16 v[32:47], v[140:143], v[132:135], v[32:47]
    v_exp_f32 v79, v79
    v_cvt_pk_bf16_f32 v94, v76, v77
    v_exp_f32 v16, v16
    v_exp_f32 v17, v17
    v_cvt_pk_bf16_f32 v95, v78, v79
    v_exp_f32 v18, v18
    v_exp_f32 v19, v19
    v_cvt_pk_bf16_f32 v80, v16, v17
    v_mfma_f32_32x32x16_bf16 v[112:127], v[160:163], v[92:95], v[112:127]
    s_waitcnt lgkmcnt(0)
    v_exp_f32 v20, v20
    v_exp_f32 v21, v21
    v_cvt_pk_bf16_f32 v81, v18, v19
    v_exp_f32 v22, v22
    v_mfma_f32_32x32x4_2b_bf16 v[48:79], v[144:145], v[138:139], 0 cbsz:1 abid:1
    v_exp_f32 v23, v23
    v_cvt_pk_bf16_f32 v82, v20, v21
    v_exp_f32 v24, v24
    v_exp_f32 v25, v25
    v_cvt_pk_bf16_f32 v83, v22, v23
    v_exp_f32 v26, v26
    v_exp_f32 v27, v27
    v_cvt_pk_bf16_f32 v84, v24, v25
    v_exp_f32 v28, v28
    v_exp_f32 v29, v29
    v_cvt_pk_bf16_f32 v85, v26, v27
    v_mfma_f32_32x32x16_bf16 v[96:111], v[148:151], v[80:83], v[96:111]
    ds_read_b128 v[156:159], v165 offset:3648
    v_exp_f32 v30, v30
    v_exp_f32 v31, v31
    v_cvt_pk_bf16_f32 v86, v28, v29
    v_exp_f32 v32, v32
    v_exp_f32 v33, v33
    v_cvt_pk_bf16_f32 v87, v30, v31
    v_mfma_f32_32x32x16_bf16 v[48:63], v[168:171], v[128:131], v[48:63]
    ds_read_b128 v[160:163], v165 offset:4256
    v_exp_f32 v34, v34
    v_exp_f32 v35, v35
    v_cvt_pk_bf16_f32 v88, v32, v33
    s_add_u32 m0, s59, 64512
    s_add_u32 s58, s58, 64512
    buffer_load_dwordx4 v3, s[20:23], s58 offen lds
    v_exp_f32 v36, v36
    v_exp_f32 v37, v37
    v_cvt_pk_bf16_f32 v89, v34, v35
    v_mfma_f32_32x32x16_bf16 v[96:111], v[152:155], v[84:87], v[96:111]
    ds_read_b128 v[140:143], v164 offset:19456
    v_exp_f32 v38, v38
    v_exp_f32 v39, v39
    v_cvt_pk_bf16_f32 v90, v36, v37
    v_exp_f32 v40, v40
    v_exp_f32 v41, v41
    v_cvt_pk_bf16_f32 v91, v38, v39
    v_exp_f32 v42, v42
    v_exp_f32 v43, v43
    v_cvt_pk_bf16_f32 v92, v40, v41
    v_mfma_f32_32x32x16_bf16 v[112:127], v[148:151], v[88:91], v[112:127]
    v_exp_f32 v44, v44
    v_exp_f32 v45, v45
    v_cvt_pk_bf16_f32 v93, v42, v43
    v_exp_f32 v46, v46
    v_mfma_f32_32x32x16_bf16 v[64:79], v[168:171], v[132:135], v[64:79]
    v_exp_f32 v47, v47
    v_cvt_pk_bf16_f32 v94, v44, v45
    v_exp_f32 v48, v48
    v_exp_f32 v49, v49
    v_cvt_pk_bf16_f32 v95, v46, v47
    v_exp_f32 v50, v50
    v_exp_f32 v51, v51
    v_cvt_pk_bf16_f32 v80, v48, v49
    v_mfma_f32_32x32x16_bf16 v[112:127], v[152:155], v[92:95], v[112:127]
    s_waitcnt lgkmcnt(0)
    v_exp_f32 v52, v52
    v_exp_f32 v53, v53
    v_cvt_pk_bf16_f32 v81, v50, v51
    v_exp_f32 v54, v54
    v_mfma_f32_32x32x4_2b_bf16 v[16:47], v[146:147], v[136:137], 0 cbsz:1 abid:0
    v_exp_f32 v55, v55
    v_cvt_pk_bf16_f32 v82, v52, v53
    v_exp_f32 v56, v56
    v_exp_f32 v57, v57
    v_cvt_pk_bf16_f32 v83, v54, v55
    v_exp_f32 v58, v58
    v_exp_f32 v59, v59
    v_cvt_pk_bf16_f32 v84, v56, v57
    v_exp_f32 v60, v60
    v_exp_f32 v61, v61
    v_cvt_pk_bf16_f32 v85, v58, v59
    v_mfma_f32_32x32x16_bf16 v[96:111], v[156:159], v[80:83], v[96:111]
    ds_read_b128 v[148:151], v165 offset:19456
    v_exp_f32 v62, v62
    v_exp_f32 v63, v63
    v_cvt_pk_bf16_f32 v86, v60, v61
    s_add_u32 m0, s59, 72576
    s_add_u32 s58, s58, 64512
    buffer_load_dwordx4 v3, s[20:23], s58 offen lds
    v_exp_f32 v64, v64
    v_exp_f32 v65, v65
    v_cvt_pk_bf16_f32 v87, v62, v63
    v_mfma_f32_32x32x16_bf16 v[16:31], v[140:143], v[128:131], v[16:31]
    ds_read_b128 v[152:155], v165 offset:20064
    v_exp_f32 v66, v66
    v_exp_f32 v67, v67
    v_cvt_pk_bf16_f32 v88, v64, v65
    v_exp_f32 v68, v68
    v_exp_f32 v69, v69
    v_cvt_pk_bf16_f32 v89, v66, v67
    v_mfma_f32_32x32x16_bf16 v[96:111], v[160:163], v[84:87], v[96:111]
    ds_read_b128 v[168:171], v164 offset:20480
    v_exp_f32 v70, v70
    v_exp_f32 v71, v71
    v_cvt_pk_bf16_f32 v90, v68, v69
    v_exp_f32 v72, v72
    v_exp_f32 v73, v73
    v_cvt_pk_bf16_f32 v91, v70, v71
    s_cmp_ge_u32 s3, 3
    s_cbranch_scc1 L_nwo
    s_add_u32 m0, s59, 80640
    s_add_u32 s58, s58, 64512
    buffer_load_dwordx4 v3, s[20:23], s58 offen lds
L_nwo:
    v_exp_f32 v74, v74
    v_exp_f32 v75, v75
    v_cvt_pk_bf16_f32 v92, v72, v73
    v_mfma_f32_32x32x16_bf16 v[112:127], v[156:159], v[88:91], v[112:127]
    v_exp_f32 v76, v76
    v_exp_f32 v77, v77
    v_cvt_pk_bf16_f32 v93, v74, v75
    v_exp_f32 v78, v78
    v_mfma_f32_32x32x16_bf16 v[32:47], v[140:143], v[132:135], v[32:47]
    v_exp_f32 v79, v79
    v_cvt_pk_bf16_f32 v94, v76, v77
    v_exp_f32 v16, v16
    v_exp_f32 v17, v17
    v_cvt_pk_bf16_f32 v95, v78, v79
    v_exp_f32 v18, v18
    v_exp_f32 v19, v19
    v_cvt_pk_bf16_f32 v80, v16, v17
    v_mfma_f32_32x32x16_bf16 v[112:127], v[160:163], v[92:95], v[112:127]
    s_waitcnt lgkmcnt(0)
    v_exp_f32 v20, v20
    v_exp_f32 v21, v21
    v_cvt_pk_bf16_f32 v81, v18, v19
    v_exp_f32 v22, v22
    v_mfma_f32_32x32x4_2b_bf16 v[48:79], v[146:147], v[136:137], 0 cbsz:1 abid:1
    v_exp_f32 v23, v23
    v_cvt_pk_bf16_f32 v82, v20, v21
    v_exp_f32 v24, v24
    v_exp_f32 v25, v25
    v_cvt_pk_bf16_f32 v83, v22, v23
    v_exp_f32 v26, v26
    v_exp_f32 v27, v27
    v_cvt_pk_bf16_f32 v84, v24, v25
    v_exp_f32 v28, v28
    v_exp_f32 v29, v29
    v_cvt_pk_bf16_f32 v85, v26, v27
    v_mfma_f32_32x32x16_bf16 v[96:111], v[148:151], v[80:83], v[96:111]
    ds_read_b128 v[156:159], v165 offset:20672
    v_exp_f32 v30, v30
    v_exp_f32 v31, v31
    v_cvt_pk_bf16_f32 v86, v28, v29
    v_exp_f32 v32, v32
    v_exp_f32 v33, v33
    v_cvt_pk_bf16_f32 v87, v30, v31
    v_mfma_f32_32x32x16_bf16 v[48:63], v[168:171], v[128:131], v[48:63]
    ds_read_b128 v[160:163], v165 offset:21280
    v_exp_f32 v34, v34
    v_exp_f32 v35, v35
    v_cvt_pk_bf16_f32 v88, v32, v33
    v_exp_f32 v36, v36
    v_exp_f32 v37, v37
    v_cvt_pk_bf16_f32 v89, v34, v35
    v_mfma_f32_32x32x16_bf16 v[96:111], v[152:155], v[84:87], v[96:111]
    ds_read_b128 v[140:143], v164 offset:21504
    v_exp_f32 v38, v38
    v_exp_f32 v39, v39
    v_cvt_pk_bf16_f32 v90, v36, v37
    v_exp_f32 v40, v40
    v_exp_f32 v41, v41
    v_cvt_pk_bf16_f32 v91, v38, v39
    v_exp_f32 v42, v42
    v_exp_f32 v43, v43
    v_cvt_pk_bf16_f32 v92, v40, v41
    v_mfma_f32_32x32x16_bf16 v[112:127], v[148:151], v[88:91], v[112:127]
    v_exp_f32 v44, v44
    v_exp_f32 v45, v45
    v_cvt_pk_bf16_f32 v93, v42, v43
    v_exp_f32 v46, v46
    v_mfma_f32_32x32x16_bf16 v[64:79], v[168:171], v[132:135], v[64:79]
    v_exp_f32 v47, v47
    v_cvt_pk_bf16_f32 v94, v44, v45
    v_exp_f32 v48, v48
    v_exp_f32 v49, v49
    v_cvt_pk_bf16_f32 v95, v46, v47
    v_exp_f32 v50, v50
    v_exp_f32 v51, v51
    v_cvt_pk_bf16_f32 v80, v48, v49
    v_mfma_f32_32x32x16_bf16 v[112:127], v[152:155], v[92:95], v[112:127]
    s_waitcnt lgkmcnt(0)
    v_exp_f32 v52, v52
    v_exp_f32 v53, v53
    v_cvt_pk_bf16_f32 v81, v50, v51
    v_exp_f32 v54, v54
    v_mfma_f32_32x32x4_2b_bf16 v[16:47], v[146:147], v[138:139], 0 cbsz:1 abid:0
    v_exp_f32 v55, v55
    v_cvt_pk_bf16_f32 v82, v52, v53
    v_exp_f32 v56, v56
    v_exp_f32 v57, v57
    v_cvt_pk_bf16_f32 v83, v54, v55
    v_exp_f32 v58, v58
    v_exp_f32 v59, v59
    v_cvt_pk_bf16_f32 v84, v56, v57
    v_exp_f32 v60, v60
    v_exp_f32 v61, v61
    v_cvt_pk_bf16_f32 v85, v58, v59
    v_mfma_f32_32x32x16_bf16 v[96:111], v[156:159], v[80:83], v[96:111]
    ds_read_b128 v[148:151], v165 offset:21888
    v_exp_f32 v62, v62
    v_exp_f32 v63, v63
    v_cvt_pk_bf16_f32 v86, v60, v61
    buffer_load_dwordx2 v[176:177], v180, s[28:31], s57 offen sc1
    v_exp_f32 v64, v64
    v_exp_f32 v65, v65
    v_cvt_pk_bf16_f32 v87, v62, v63
    v_mfma_f32_32x32x16_bf16 v[16:31], v[140:143], v[128:131], v[16:31]
    ds_read_b128 v[152:155], v165 offset:22496
    v_exp_f32 v66, v66
    v_exp_f32 v67, v67
    v_cvt_pk_bf16_f32 v88, v64, v65
    v_exp_f32 v68, v68
    v_exp_f32 v69, v69
    v_cvt_pk_bf16_f32 v89, v66, v67
    v_mfma_f32_32x32x16_bf16 v[96:111], v[160:163], v[84:87], v[96:111]
    ds_read_b128 v[168:171], v164 offset:22528
    v_exp_f32 v70, v70
    v_exp_f32 v71, v71
    v_cvt_pk_bf16_f32 v90, v68, v69
    v_exp_f32 v72, v72
    v_exp_f32 v73, v73
    v_cvt_pk_bf16_f32 v91, v70, v71
    v_exp_f32 v74, v74
    v_exp_f32 v75, v75
    v_cvt_pk_bf16_f32 v92, v72, v73
    v_mfma_f32_32x32x16_bf16 v[112:127], v[156:159], v[88:91], v[112:127]
    v_exp_f32 v76, v76
    v_exp_f32 v77, v77
    v_cvt_pk_bf16_f32 v93, v74, v75
    v_exp_f32 v78, v78
    v_mfma_f32_32x32x16_bf16 v[32:47], v[140:143], v[132:135], v[32:47]
    v_exp_f32 v79, v79
    v_cvt_pk_bf16_f32 v94, v76, v77
    s_setprio 0
    v_exp_f32 v16, v16
    v_exp_f32 v17, v17
    v_cvt_pk_bf16_f32 v95, v78, v79
    v_exp_f32 v18, v18
    v_exp_f32 v19, v19
    v_cvt_pk_bf16_f32 v80, v16, v17
    v_mfma_f32_32x32x16_bf16 v[112:127], v[160:163], v[92:95], v[112:127]
    s_waitcnt lgkmcnt(0)
    v_exp_f32 v20, v20
    v_exp_f32 v21, v21
    v_cvt_pk_bf16_f32 v81, v18, v19
    v_exp_f32 v22, v22
    v_mfma_f32_32x32x4_2b_bf16 v[48:79], v[146:147], v[138:139], 0 cbsz:1 abid:1
    v_exp_f32 v23, v23
    v_cvt_pk_bf16_f32 v82, v20, v21
    v_exp_f32 v24, v24
    v_exp_f32 v25, v25
    v_cvt_pk_bf16_f32 v83, v22, v23
    v_exp_f32 v26, v26
    v_exp_f32 v27, v27
    v_cvt_pk_bf16_f32 v84, v24, v25
    v_exp_f32 v28, v28
    v_exp_f32 v29, v29
    v_cvt_pk_bf16_f32 v85, v26, v27
    v_mfma_f32_32x32x16_bf16 v[96:111], v[148:151], v[80:83], v[96:111]
    ds_read_b128 v[156:159], v165 offset:23104
    v_exp_f32 v30, v30
    v_exp_f32 v31, v31
    v_cvt_pk_bf16_f32 v86, v28, v29
    v_exp_f32 v32, v32
    v_exp_f32 v33, v33
    v_cvt_pk_bf16_f32 v87, v30, v31
    v_mfma_f32_32x32x16_bf16 v[48:63], v[168:171], v[128:131], v[48:63]
    ds_read_b128 v[160:163], v165 offset:23712
    v_exp_f32 v34, v34
    v_exp_f32 v35, v35
    v_cvt_pk_bf16_f32 v88, v32, v33
    v_exp_f32 v36, v36
    v_exp_f32 v37, v37
    v_cvt_pk_bf16_f32 v89, v34, v35
    v_mfma_f32_32x32x16_bf16 v[96:111], v[152:155], v[84:87], v[96:111]
    v_exp_f32 v38, v38
    v_exp_f32 v39, v39
    v_cvt_pk_bf16_f32 v90, v36, v37
    v_exp_f32 v40, v40
    v_exp_f32 v41, v41
    v_cvt_pk_bf16_f32 v91, v38, v39
    v_exp_f32 v42, v42
    v_exp_f32 v43, v43
    v_cvt_pk_bf16_f32 v92, v40, v41
    v_mfma_f32_32x32x16_bf16 v[112:127], v[148:151], v[88:91], v[112:127]
    v_exp_f32 v44, v44
    v_exp_f32 v45, v45
    v_cvt_pk_bf16_f32 v93, v42, v43
    v_exp_f32 v46, v46
    v_mfma_f32_32x32x16_bf16 v[64:79], v[168:171], v[132:135], v[64:79]
    v_exp_f32 v47, v47
    v_cvt_pk_bf16_f32 v94, v44, v45
    v_exp_f32 v48, v48
    v_exp_f32 v49, v49
    v_cvt_pk_bf16_f32 v95, v46, v47
    v_exp_f32 v50, v50
    v_exp_f32 v51, v51
    v_cvt_pk_bf16_f32 v80, v48, v49
    v_mfma_f32_32x32x16_bf16 v[112:127], v[152:155], v[92:95], v[112:127]
    s_waitcnt lgkmcnt(0)
    v_exp_f32 v52, v52
    v_exp_f32 v53, v53
    v_cvt_pk_bf16_f32 v81, v50, v51
    v_exp_f32 v54, v54
    v_exp_f32 v55, v55
    v_cvt_pk_bf16_f32 v82, v52, v53
    v_exp_f32 v56, v56
    v_exp_f32 v57, v57
    v_cvt_pk_bf16_f32 v83, v54, v55
    v_exp_f32 v58, v58
    v_exp_f32 v59, v59
    v_cvt_pk_bf16_f32 v84, v56, v57
    v_exp_f32 v60, v60
    v_exp_f32 v61, v61
    v_cvt_pk_bf16_f32 v85, v58, v59
    v_mfma_f32_32x32x16_bf16 v[96:111], v[156:159], v[80:83], v[96:111]
    v_exp_f32 v62, v62
    v_exp_f32 v63, v63
    v_cvt_pk_bf16_f32 v86, v60, v61
    v_exp_f32 v64, v64
    v_exp_f32 v65, v65
    v_cvt_pk_bf16_f32 v87, v62, v63
    v_exp_f32 v66, v66
    v_exp_f32 v67, v67
    v_cvt_pk_bf16_f32 v88, v64, v65
    v_exp_f32 v68, v68
    v_exp_f32 v69, v69
    v_cvt_pk_bf16_f32 v89, v66, v67
    v_mfma_f32_32x32x16_bf16 v[96:111], v[160:163], v[84:87], v[96:111]
    v_exp_f32 v70, v70
    v_exp_f32 v71, v71
    v_cvt_pk_bf16_f32 v90, v68, v69
    v_exp_f32 v72, v72
    v_exp_f32 v73, v73
    v_cvt_pk_bf16_f32 v91, v70, v71
    v_exp_f32 v74, v74
    v_exp_f32 v75, v75
    v_cvt_pk_bf16_f32 v92, v72, v73
    v_mfma_f32_32x32x16_bf16 v[112:127], v[156:159], v[88:91], v[112:127]
    v_exp_f32 v76, v76
    v_exp_f32 v77, v77
    v_cvt_pk_bf16_f32 v93, v74, v75
    v_exp_f32 v78, v78
    v_exp_f32 v79, v79
    v_cvt_pk_bf16_f32 v94, v76, v77
    v_cvt_pk_bf16_f32 v95, v78, v79
    s_mul_i32 s34, s3, 2560
    s_add_u32 s35, s34, 142848
    s_add_u32 s34, s34, 83968
    s_cmp_ge_u32 s3, 5
    v_mfma_f32_32x32x16_bf16 v[112:127], v[160:163], v[92:95], v[112:127]
    s_cselect_b32 s34, s35, s34
    v_add_u32 v12, s34, v5
    s_xor_b32 s33, s3, 4
    s_mul_i32 s34, s33, 2560
    s_add_u32 s35, s34, 142848
    s_add_u32 s34, s34, 83968
    s_cmp_ge_u32 s33, 5
    s_cselect_b32 s34, s35, s34
    v_add_u32 v13, s34, v5
    v_mov_b32 v40, 0
    v_mov_b32 v41, 0
    v_mov_b32 v42, 0
    s_nop 3
    ds_write_b128 v12, v[112:115]
    ds_write_b128 v12, v[116:119] offset:1024
    s_mov_b32 exec_hi, 0
    ds_write_b128 v12, v[120:123] offset:2048
    s_mov_b32 exec_hi, -1
    s_waitcnt vmcnt(0) lgkmcnt(0)
    s_barrier
    ds_read_b128 v[32:35], v13
    ds_read_b128 v[36:39], v13 offset:1024
    s_mov_b32 exec_hi, 0
    ds_read_b128 v[40:43], v13 offset:2048
    s_mov_b32 exec_hi, -1
    s_lshl_b32 s54, s4, 3
    s_mul_i32 s54, s54, 9216
    s_add_u32 s54, s54, 262144
    s_mul_i32 s55, s5, 9216
    s_add_u32 s55, s55, s54
    s_lshl_b32 s34, s3, 10
    s_add_u32 s52, s34, s54
    s_add_u32 s34, s34, s55
    s_lshl_b32 s35, s7, 9
    s_add_u32 s35, s35, s55
    s_lshl_b32 s33, s6, 2
    s_add_u32 s35, s35, s33
    s_add_u32 s35, s35, 8192
    s_mul_i32 s53, s3, 9216
    s_add_u32 s53, s53, s54
    s_add_u32 s53, s53, 8192
    s_waitcnt lgkmcnt(0)
    v_add_f32 v26, v106, v42
    v_add_f32 v16, v96, v32
    v_add_f32 v17, v97, v33
    v_add_f32 v18, v98, v34
    v_add_f32 v19, v99, v35
    v_add_f32 v20, v100, v36
    v_add_f32 v21, v101, v37
    v_add_f32 v22, v102, v38
    v_add_f32 v23, v103, v39
    v_add_f32 v24, v104, v40
    v_add_f32 v25, v105, v41
    v_mov_b32 v27, v26
    v_add_f32 v28, |v16|, |v17|
    v_add_f32 v29, |v18|, |v19|
    v_permlane32_swap_b32 v26, v27
    v_add_f32 v28, |v20|, v28
    v_add_f32 v29, |v21|, v29
    v_rcp_f32 v27, v26
    v_add_f32 v28, |v22|, v28
    v_add_f32 v29, |v23|, v29
    v_add_f32 v28, |v24|, v28
    v_add_f32 v29, |v25|, v29
    v_cmp_nle_f32 vcc, 0x21800000, v26
    v_add_f32 v28, v29, v28
    s_mov_b64 s[32:33], vcc
    v_cmp_nge_f32 vcc, 0x71800000, v26
    s_or_b64 s[32:33], s[32:33], vcc
    v_cmp_nge_f32 vcc, 0x7e800000, v28
    s_or_b64 vcc, s[32:33], vcc
    s_cbranch_vccnz L_slow
L_onorm:
    v_mul_f32 v16, v16, v27
    v_mul_f32 v17, v17, v27
    v_mul_f32 v18, v18, v27
    v_mul_f32 v19, v19, v27
    v_mul_f32 v20, v20, v27
    v_mul_f32 v21, v21, v27
    v_mul_f32 v22, v22, v27
    v_mul_f32 v23, v23, v27
    v_mul_f32 v24, v24, v27
    v_mul_f32 v25, v25, v27
    v_cvt_pk_bf16_f32 v32, v16, v17
    v_cvt_pk_bf16_f32 v33, v18, v19
    v_cvt_pk_bf16_f32 v34, v20, v21
    v_cvt_pk_bf16_f32 v35, v22, v23
    v_cvt_pk_bf16_f32 v36, v24, v25
    v_min_u32 v32, -2, v32
    v_min_u32 v33, -2, v33
    v_min_u32 v34, -2, v34
    v_min_u32 v35, -2, v35
    v_min_u32 v36, -2, v36
    buffer_store_dwordx4 v[32:35], v5, s[28:31], s34 offen sc1
    s_mov_b32 exec_hi, 0
    buffer_store_dword v36, v5, s[28:31], s35 offen sc1
    s_mov_b32 exec_hi, -1
    v_cmp_ne_u64 vcc, v[176:177], v[172:173]
    s_cbranch_vccnz L_sfpoll
L_sfok:
    s_cmp_lg_u32 s2, 0
    s_cbranch_scc1 L_noep
    s_cmp_lg_u32 s3, 0
    s_cbranch_scc1 L_noep
    v_mov_b32 v12, 253952
    s_mov_b64 exec, 1
    buffer_store_dwordx2 v[172:173], v12, s[28:31], 0 offen sc1
    s_mov_b64 exec, -1
    s_waitcnt vmcnt(0)
L_noep:
    s_mul_i32 s34, s7, 36864
    s_add_u32 s34, s34, 85248
    s_lshl_b32 s35, s6, 10
    s_add_u32 s35, s35, s34
    v_add_u32 v6, s35, v5
    s_lshl_b32 s35, s3, 9
    s_add_u32 s35, s35, 118016
    v_lshrrev_b32 v13, 5, v1
    v_mul_u32_u24 v7, 36352, v13
    v_add3_u32 v7, v7, v5, s35
    v_and_b32 v12, 15, v1
    v_lshrrev_b32 v14, 4, v1
    v_lshlrev_b32 v8, 9, v14
    v_lshl_add_u32 v8, v12, 4, v8
    v_add_u32 v8, s34, v8
    v_bfe_u32 v15, v1, 2, 2
    v_and_b32 v11, 3, v1
    v_lshlrev_b32 v11, 3, v11
    v_mul_u32_u24 v2, 18, v13
    v_and_b32 v3, 1, v14
    v_lshl_add_u32 v2, v3, 2, v2
    v_add_u32 v2, v2, v15
    v_mul_u32_u24 v2, 144, v2
    v_lshrrev_b32 v4, 1, v15
    v_lshl_add_u32 v4, v14, 2, v4
    v_mul_u32_u24 v4, 18, v4
    v_and_b32 v3, 1, v15
    v_add3_u32 v4, v4, v3, 16
    v_mul_u32_u24 v4, 144, v4
    s_mul_i32 s59, s4, 73728
    s_mul_i32 s35, s7, 36864
    s_add_u32 s59, s59, s35
    s_mul_i32 s35, s5, 144
    s_add_u32 s59, s59, s35
    v_mul_u32_u24 v10, 1152, v12
    v_lshl_add_u32 v10, v14, 3, v10
    s_barrier
    s_lshl_b32 s58, s6, 5
    v_add_u32 v12, s58, v11
    v_add_u32 v13, v12, v2
    v_add_u32 v14, 41472, v13
    v_add_u32 v15, v12, v4
    ds_read_b64_tr_b16 v[32:33], v13 offset:0
    ds_read_b64_tr_b16 v[34:35], v13 offset:1152
    ds_read_b64_tr_b16 v[36:37], v13 offset:5184
    ds_read_b64_tr_b16 v[38:39], v13 offset:6336
    ds_read_b64_tr_b16 v[40:41], v13 offset:10368
    ds_read_b64_tr_b16 v[42:43], v13 offset:11520
    ds_read_b64_tr_b16 v[44:45], v13 offset:15552
    ds_read_b64_tr_b16 v[46:47], v13 offset:16704
    s_waitcnt lgkmcnt(6)
    ds_read_b64_tr_b16 v[48:49], v13 offset:20736
    ds_read_b64_tr_b16 v[50:51], v13 offset:21888
    ds_read_b64_tr_b16 v[52:53], v13 offset:25920
    ds_read_b64_tr_b16 v[54:55], v13 offset:27072
    ds_read_b64_tr_b16 v[56:57], v13 offset:31104
    ds_read_b64_tr_b16 v[58:59], v13 offset:32256
    ds_read_b64_tr_b16 v[60:61], v13 offset:36288
    ds_read_b64_tr_b16 v[62:63], v13 offset:37440
    s_waitcnt lgkmcnt(6)
    ds_read_b64_tr_b16 v[64:65], v14 offset:0
    ds_read_b64_tr_b16 v[66:67], v14 offset:1152
    ds_read_b64_tr_b16 v[68:69], v14 offset:5184
    ds_read_b64_tr_b16 v[70:71], v14 offset:6336
    ds_read_b64_tr_b16 v[72:73], v14 offset:10368
    ds_read_b64_tr_b16 v[74:75], v14 offset:11520
    ds_read_b64_tr_b16 v[76:77], v14 offset:15552
    ds_read_b64_tr_b16 v[78:79], v14 offset:16704
    s_waitcnt lgkmcnt(6)
    ds_read_b64_tr_b16 v[80:81], v14 offset:20736
    ds_read_b64_tr_b16 v[82:83], v14 offset:21888
    ds_read_b64_tr_b16 v[84:85], v14 offset:25920
    ds_read_b64_tr_b16 v[86:87], v14 offset:27072
    ds_read_b64_tr_b16 v[88:89], v14 offset:31104
    ds_read_b64_tr_b16 v[90:91], v14 offset:32256
    ds_read_b64_tr_b16 v[92:93], v14 offset:36288
    ds_read_b64_tr_b16 v[94:95], v14 offset:37440
    s_waitcnt lgkmcnt(6)
    ds_read_b64_tr_b16 v[96:97], v15 offset:0
    ds_read_b64_tr_b16 v[98:99], v15 offset:5184
    ds_read_b64_tr_b16 v[100:101], v15 offset:41472
    ds_read_b64_tr_b16 v[102:103], v15 offset:46656
    s_add_u32 s34, s3, 2
    s_bitcmp1_b32 s34, 2
    s_cbranch_scc1 L_gplain
    s_setprio 2
    s_add_u32 s33, s52, 0
    buffer_load_dwordx4 v[184:187], v5, s[28:31], s33 offen sc1
    s_add_u32 s33, s52, 9216
    buffer_load_dwordx4 v[188:191], v5, s[28:31], s33 offen sc1
    s_add_u32 s33, s52, 18432
    buffer_load_dwordx4 v[192:195], v5, s[28:31], s33 offen sc1
    s_setprio 1
    s_add_u32 s33, s52, 27648
    buffer_load_dwordx4 v[196:199], v5, s[28:31], s33 offen sc1
    s_add_u32 s33, s52, 36864
    buffer_load_dwordx4 v[200:203], v5, s[28:31], s33 offen sc1
    s_add_u32 s33, s52, 46080
    buffer_load_dwordx4 v[204:207], v5, s[28:31], s33 offen sc1
    s_setprio 0
    s_add_u32 s33, s52, 55296
    buffer_load_dwordx4 v[208:211], v5, s[28:31], s33 offen sc1
    s_add_u32 s33, s52, 64512
    buffer_load_dwordx4 v[212:215], v5, s[28:31], s33 offen sc1
    buffer_load_dwordx4 v[216:219], v5, s[28:31], s53 offen sc1
    v_and_b32 v12, 8, v11
    v_add_u32 v12, 128, v12
    v_add_u32 v13, v12, v2
    v_add_u32 v14, 41472, v13
    v_add_u32 v15, v12, v4
    ds_read_b64_tr_b16 v[104:105], v13 offset:0
    ds_read_b64_tr_b16 v[106:107], v13 offset:1152
    ds_read_b64_tr_b16 v[108:109], v13 offset:5184
    ds_read_b64_tr_b16 v[110:111], v13 offset:6336
    ds_read_b64_tr_b16 v[112:113], v13 offset:10368
    ds_read_b64_tr_b16 v[114:115], v13 offset:11520
    ds_read_b64_tr_b16 v[116:117], v13 offset:15552
    ds_read_b64_tr_b16 v[118:119], v13 offset:16704
    s_waitcnt lgkmcnt(6)
    ds_read_b64_tr_b16 v[120:121], v13 offset:20736
    ds_read_b64_tr_b16 v[122:123], v13 offset:21888
    ds_read_b64_tr_b16 v[124:125], v13 offset:25920
    ds_read_b64_tr_b16 v[126:127], v13 offset:27072
    ds_read_b64_tr_b16 v[128:129], v13 offset:31104
    ds_read_b64_tr_b16 v[130:131], v13 offset:32256
    ds_read_b64_tr_b16 v[132:133], v13 offset:36288
    ds_read_b64_tr_b16 v[134:135], v13 offset:37440
    s_waitcnt lgkmcnt(6)
    ds_read_b64_tr_b16 v[136:137], v14 offset:0
    ds_read_b64_tr_b16 v[138:139], v14 offset:1152
    ds_read_b64_tr_b16 v[140:141], v14 offset:5184
    ds_read_b64_tr_b16 v[142:143], v14 offset:6336
    ds_read_b64_tr_b16 v[144:145], v14 offset:10368
    ds_read_b64_tr_b16 v[146:147], v14 offset:11520
    ds_read_b64_tr_b16 v[148:149], v14 offset:15552
    ds_read_b64_tr_b16 v[150:151], v14 offset:16704
    s_waitcnt lgkmcnt(6)
    ds_read_b64_tr_b16 v[152:153], v14 offset:20736
    ds_read_b64_tr_b16 v[154:155], v14 offset:21888
    ds_read_b64_tr_b16 v[156:157], v14 offset:25920
    ds_read_b64_tr_b16 v[158:159], v14 offset:27072
    ds_read_b64_tr_b16 v[160:161], v14 offset:31104
    ds_read_b64_tr_b16 v[162:163], v14 offset:32256
    ds_read_b64_tr_b16 v[164:165], v14 offset:36288
    ds_read_b64_tr_b16 v[166:167], v14 offset:37440
    s_waitcnt lgkmcnt(6)
    ds_read_b64_tr_b16 v[168:169], v15 offset:0
    ds_read_b64_tr_b16 v[170:171], v15 offset:5184
    ds_read_b64_tr_b16 v[172:173], v15 offset:41472
    ds_read_b64_tr_b16 v[174:175], v15 offset:46656
    s_waitcnt lgkmcnt(0)
    s_bitcmp1_b32 s3, 0
    s_cbranch_scc1 L_gx1
    s_mov_b32 s56, 0
    s_waitcnt vmcnt(6)
L_oga0:
    v_max3_u32 v12, v184, v185, v186
    v_max3_u32 v12, v187, v188, v12
    v_max3_u32 v12, v189, v190, v12
    v_max3_u32 v12, v191, v192, v12
    v_max3_u32 v12, v193, v194, v12
    v_max_u32 v12, v195, v12
    v_cmp_eq_u32 vcc, -1, v12
    s_cbranch_vccz L_ogoka0
    s_add_u32 s56, s56, 1
    s_bitcmp1_b32 s56, 18
    s_cbranch_scc1 L_ogoka0
    s_add_u32 s33, s52, 0
    buffer_load_dwordx4 v[184:187], v5, s[28:31], s33 offen sc1
    s_add_u32 s33, s52, 9216
    buffer_load_dwordx4 v[188:191], v5, s[28:31], s33 offen sc1
    s_add_u32 s33, s52, 18432
    buffer_load_dwordx4 v[192:195], v5, s[28:31], s33 offen sc1
    s_waitcnt vmcnt(0)
    s_branch L_oga0
L_ogoka0:
    ds_write_b128 v6, v[184:187] offset:0
    ds_write_b128 v6, v[188:191] offset:4096
    ds_write_b128 v6, v[192:195] offset:8192
    s_mov_b32 s56, 0
    s_waitcnt vmcnt(3)
L_oga1:
    v_max3_u32 v12, v196, v197, v198
    v_max3_u32 v12, v199, v200, v12
    v_max3_u32 v12, v201, v202, v12
    v_max3_u32 v12, v203, v204, v12
    v_max3_u32 v12, v205, v206, v12
    v_max_u32 v12, v207, v12
    v_cmp_eq_u32 vcc, -1, v12
    s_cbranch_vccz L_ogoka1
    s_add_u32 s56, s56, 1
    s_bitcmp1_b32 s56, 18
    s_cbranch_scc1 L_ogoka1
    s_add_u32 s33, s52, 27648
    buffer_load_dwordx4 v[196:199], v5, s[28:31], s33 offen sc1
    s_add_u32 s33, s52, 36864
    buffer_load_dwordx4 v[200:203], v5, s[28:31], s33 offen sc1
    s_add_u32 s33, s52, 46080
    buffer_load_dwordx4 v[204:207], v5, s[28:31], s33 offen sc1
    s_waitcnt vmcnt(0)
    s_branch L_oga1
L_ogoka1:
    ds_write_b128 v6, v[196:199] offset:12288
    ds_write_b128 v6, v[200:203] offset:16384
    ds_write_b128 v6, v[204:207] offset:20480
    s_mov_b32 s56, 0
    s_waitcnt vmcnt(0)
L_oga2:
    v_max3_u32 v12, v208, v209, v210
    v_max3_u32 v12, v211, v212, v12
    v_max3_u32 v12, v213, v214, v12
    v_max3_u32 v12, v215, v216, v12
    v_max3_u32 v12, v217, v218, v12
    v_max_u32 v12, v219, v12
    v_cmp_eq_u32 vcc, -1, v12
    s_cbranch_vccz L_ogoka2
    s_add_u32 s56, s56, 1
    s_bitcmp1_b32 s56, 18
    s_cbranch_scc1 L_ogoka2
    s_add_u32 s33, s52, 55296
    buffer_load_dwordx4 v[208:211], v5, s[28:31], s33 offen sc1
    s_add_u32 s33, s52, 64512
    buffer_load_dwordx4 v[212:215], v5, s[28:31], s33 offen sc1
    buffer_load_dwordx4 v[216:219], v5, s[28:31], s53 offen sc1
    s_waitcnt vmcnt(0)
    s_branch L_oga2
L_ogoka2:
    ds_write_b128 v6, v[208:211] offset:24576
    ds_write_b128 v6, v[212:215] offset:28672
    ds_write_b128 v7, v[216:219]
    s_waitcnt lgkmcnt(0)
    s_barrier
    s_lshl_b32 s35, s6, 5
    s_add_u32 s34, s59, s35
    s_add_u32 s35, s34, 18432
    s_add_u32 s33, s59, 128
    ds_read_b128 v[220:223], v8 offset:0
    ds_read_b128 v[224:227], v8 offset:2048
    ds_read_b128 v[228:231], v8 offset:4096
    ds_read_b128 v[232:235], v8 offset:6144
    ds_read_b128 v[236:239], v8 offset:8192
    ds_read_b128 v[240:243], v8 offset:10240
    ds_read_b128 v[244:247], v8 offset:12288
    ds_read_b128 v[248:251], v8 offset:14336
    s_waitcnt lgkmcnt(7)
    v_mfma_f32_16x16x32_bf16 v[16:19], v[32:35], v[220:223], 0
    v_mfma_f32_16x16x32_bf16 v[24:27], v[104:107], v[220:223], 0
    ds_read_b128 v[220:223], v8 offset:16384
    s_waitcnt lgkmcnt(7)
    v_mfma_f32_16x16x32_bf16 v[16:19], v[36:39], v[224:227], v[16:19]
    v_mfma_f32_16x16x32_bf16 v[24:27], v[108:111], v[224:227], v[24:27]
    ds_read_b128 v[224:227], v8 offset:18432
    s_waitcnt lgkmcnt(7)
    v_mfma_f32_16x16x32_bf16 v[16:19], v[40:43], v[228:231], v[16:19]
    v_mfma_f32_16x16x32_bf16 v[24:27], v[112:115], v[228:231], v[24:27]
    ds_read_b128 v[228:231], v8 offset:20480
    s_waitcnt lgkmcnt(7)
    v_mfma_f32_16x16x32_bf16 v[16:19], v[44:47], v[232:235], v[16:19]
    v_mfma_f32_16x16x32_bf16 v[24:27], v[116:119], v[232:235], v[24:27]
    ds_read_b128 v[232:235], v8 offset:22528
    s_waitcnt lgkmcnt(7)
    v_mfma_f32_16x16x32_bf16 v[16:19], v[48:51], v[236:239], v[16:19]
    v_mfma_f32_16x16x32_bf16 v[24:27], v[120:123], v[236:239], v[24:27]
    ds_read_b128 v[236:239], v8 offset:24576
    s_waitcnt lgkmcnt(7)
    v_mfma_f32_16x16x32_bf16 v[16:19], v[52:55], v[240:243], v[16:19]
    v_mfma_f32_16x16x32_bf16 v[24:27], v[124:127], v[240:243], v[24:27]
    ds_read_b128 v[240:243], v8 offset:26624
    s_waitcnt lgkmcnt(7)
    v_mfma_f32_16x16x32_bf16 v[16:19], v[56:59], v[244:247], v[16:19]
    v_mfma_f32_16x16x32_bf16 v[24:27], v[128:131], v[244:247], v[24:27]
    ds_read_b128 v[244:247], v8 offset:28672
    s_waitcnt lgkmcnt(7)
    v_mfma_f32_16x16x32_bf16 v[16:19], v[60:63], v[248:251], v[16:19]
    v_mfma_f32_16x16x32_bf16 v[24:27], v[132:135], v[248:251], v[24:27]
    ds_read_b128 v[248:251], v8 offset:30720
    s_waitcnt lgkmcnt(7)
    v_mfma_f32_16x16x32_bf16 v[16:19], v[64:67], v[220:223], v[16:19]
    v_mfma_f32_16x16x32_bf16 v[24:27], v[136:139], v[220:223], v[24:27]
    ds_read_b128 v[220:223], v8 offset:32768
    s_waitcnt lgkmcnt(7)
    v_mfma_f32_16x16x32_bf16 v[16:19], v[68:71], v[224:227], v[16:19]
    v_mfma_f32_16x16x32_bf16 v[24:27], v[140:143], v[224:227], v[24:27]
    ds_read_b128 v[224:227], v8 offset:34816
    s_waitcnt lgkmcnt(7)
    v_mfma_f32_16x16x32_bf16 v[16:19], v[72:75], v[228:231], v[16:19]
    v_mfma_f32_16x16x32_bf16 v[24:27], v[144:147], v[228:231], v[24:27]
    ds_read_b128 v[228:231], v8 offset:256
    s_waitcnt lgkmcnt(7)
    v_mfma_f32_16x16x32_bf16 v[16:19], v[76:79], v[232:235], v[16:19]
    v_mfma_f32_16x16x32_bf16 v[24:27], v[148:151], v[232:235], v[24:27]
    ds_read_b128 v[232:235], v8 offset:2304
    s_waitcnt lgkmcnt(7)
    v_mfma_f32_16x16x32_bf16 v[16:19], v[80:83], v[236:239], v[16:19]
    v_mfma_f32_16x16x32_bf16 v[24:27], v[152:155], v[236:239], v[24:27]
    ds_read_b128 v[236:239], v8 offset:4352
    s_waitcnt lgkmcnt(7)
    v_mfma_f32_16x16x32_bf16 v[16:19], v[84:87], v[240:243], v[16:19]
    v_mfma_f32_16x16x32_bf16 v[24:27], v[156:159], v[240:243], v[24:27]
    ds_read_b128 v[240:243], v8 offset:6400
    s_waitcnt lgkmcnt(7)
    v_mfma_f32_16x16x32_bf16 v[16:19], v[88:91], v[244:247], v[16:19]
    v_mfma_f32_16x16x32_bf16 v[24:27], v[160:163], v[244:247], v[24:27]
    ds_read_b128 v[244:247], v8 offset:8448
    s_waitcnt lgkmcnt(7)
    v_mfma_f32_16x16x32_bf16 v[16:19], v[92:95], v[248:251], v[16:19]
    v_mfma_f32_16x16x32_bf16 v[24:27], v[164:167], v[248:251], v[24:27]
    ds_read_b128 v[248:251], v8 offset:10496
    s_waitcnt lgkmcnt(7)
    v_mfma_f32_16x16x32_bf16 v[16:19], v[96:99], v[220:223], v[16:19]
    v_mfma_f32_16x16x32_bf16 v[24:27], v[168:171], v[220:223], v[24:27]
    ds_read_b128 v[220:223], v8 offset:12544
    s_waitcnt lgkmcnt(7)
    v_mfma_f32_16x16x32_bf16 v[16:19], v[100:103], v[224:227], v[16:19]
    v_mfma_f32_16x16x32_bf16 v[24:27], v[172:175], v[224:227], v[24:27]
    ds_read_b128 v[224:227], v8 offset:14592
    s_waitcnt lgkmcnt(7)
    v_mfma_f32_16x16x32_bf16 v[20:23], v[32:35], v[228:231], 0
    ds_read_b128 v[228:231], v8 offset:16640
    s_waitcnt lgkmcnt(7)
    v_mfma_f32_16x16x32_bf16 v[20:23], v[36:39], v[232:235], v[20:23]
    ds_read_b128 v[232:235], v8 offset:18688
    s_waitcnt lgkmcnt(7)
    v_mfma_f32_16x16x32_bf16 v[20:23], v[40:43], v[236:239], v[20:23]
    ds_read_b128 v[236:239], v8 offset:20736
    s_waitcnt lgkmcnt(7)
    v_mfma_f32_16x16x32_bf16 v[20:23], v[44:47], v[240:243], v[20:23]
    ds_read_b128 v[240:243], v8 offset:22784
    v_cvt_pk_bf16_f32 v28, v16, v17
    v_cvt_pk_bf16_f32 v29, v18, v19
    buffer_store_dwordx2 v[28:29], v10, s[24:27], s34 offen
    v_cvt_pk_bf16_f32 v14, v24, v25
    v_cvt_pk_bf16_f32 v15, v26, v27
    s_mov_b32 exec_hi, 0
    buffer_store_dwordx2 v[14:15], v10, s[24:27], s33 offen
    s_mov_b32 exec_hi, -1
    s_waitcnt lgkmcnt(7)
    v_mfma_f32_16x16x32_bf16 v[20:23], v[48:51], v[244:247], v[20:23]
    ds_read_b128 v[244:247], v8 offset:24832
    s_waitcnt lgkmcnt(7)
    v_mfma_f32_16x16x32_bf16 v[20:23], v[52:55], v[248:251], v[20:23]
    ds_read_b128 v[248:251], v8 offset:26880
    s_waitcnt lgkmcnt(7)
    v_mfma_f32_16x16x32_bf16 v[20:23], v[56:59], v[220:223], v[20:23]
    ds_read_b128 v[220:223], v8 offset:28928
    s_waitcnt lgkmcnt(7)
    v_mfma_f32_16x16x32_bf16 v[20:23], v[60:63], v[224:227], v[20:23]
    ds_read_b128 v[224:227], v8 offset:30976
    s_waitcnt lgkmcnt(7)
    v_mfma_f32_16x16x32_bf16 v[20:23], v[64:67], v[228:231], v[20:23]
    ds_read_b128 v[228:231], v8 offset:33024
    s_waitcnt lgkmcnt(7)
    v_mfma_f32_16x16x32_bf16 v[20:23], v[68:71], v[232:235], v[20:23]
    ds_read_b128 v[232:235], v8 offset:35072
    s_waitcnt lgkmcnt(7)
    v_mfma_f32_16x16x32_bf16 v[20:23], v[72:75], v[236:239], v[20:23]
    s_waitcnt lgkmcnt(6)
    v_mfma_f32_16x16x32_bf16 v[20:23], v[76:79], v[240:243], v[20:23]
    s_waitcnt lgkmcnt(5)
    v_mfma_f32_16x16x32_bf16 v[20:23], v[80:83], v[244:247], v[20:23]
    s_waitcnt lgkmcnt(4)
    v_mfma_f32_16x16x32_bf16 v[20:23], v[84:87], v[248:251], v[20:23]
    s_waitcnt lgkmcnt(3)
    v_mfma_f32_16x16x32_bf16 v[20:23], v[88:91], v[220:223], v[20:23]
    s_waitcnt lgkmcnt(2)
    v_mfma_f32_16x16x32_bf16 v[20:23], v[92:95], v[224:227], v[20:23]
    s_waitcnt lgkmcnt(1)
    v_mfma_f32_16x16x32_bf16 v[20:23], v[96:99], v[228:231], v[20:23]
    s_waitcnt lgkmcnt(0)
    v_mfma_f32_16x16x32_bf16 v[20:23], v[100:103], v[232:235], v[20:23]
    s_nop 7
    v_cvt_pk_bf16_f32 v30, v20, v21
    v_cvt_pk_bf16_f32 v31, v22, v23
    buffer_store_dwordx2 v[30:31], v10, s[24:27], s35 offen
    s_endpgm
L_gx1:
    s_mov_b32 s56, 0
    s_waitcnt vmcnt(6)
L_ogb0:
    v_max3_u32 v12, v184, v185, v186
    v_max3_u32 v12, v187, v188, v12
    v_max3_u32 v12, v189, v190, v12
    v_max3_u32 v12, v191, v192, v12
    v_max3_u32 v12, v193, v194, v12
    v_max_u32 v12, v195, v12
    v_cmp_eq_u32 vcc, -1, v12
    s_cbranch_vccz L_ogokb0
    s_add_u32 s56, s56, 1
    s_bitcmp1_b32 s56, 18
    s_cbranch_scc1 L_ogokb0
    s_add_u32 s33, s52, 0
    buffer_load_dwordx4 v[184:187], v5, s[28:31], s33 offen sc1
    s_add_u32 s33, s52, 9216
    buffer_load_dwordx4 v[188:191], v5, s[28:31], s33 offen sc1
    s_add_u32 s33, s52, 18432
    buffer_load_dwordx4 v[192:195], v5, s[28:31], s33 offen sc1
    s_waitcnt vmcnt(0)
    s_branch L_ogb0
L_ogokb0:
    ds_write_b128 v6, v[184:187] offset:0
    ds_write_b128 v6, v[188:191] offset:4096
    ds_write_b128 v6, v[192:195] offset:8192
    s_mov_b32 s56, 0
    s_waitcnt vmcnt(3)
L_ogb1:
    v_max3_u32 v12, v196, v197, v198
    v_max3_u32 v12, v199, v200, v12
    v_max3_u32 v12, v201, v202, v12
    v_max3_u32 v12, v203, v204, v12
    v_max3_u32 v12, v205, v206, v12
    v_max_u32 v12, v207, v12
    v_cmp_eq_u32 vcc, -1, v12
    s_cbranch_vccz L_ogokb1
    s_add_u32 s56, s56, 1
    s_bitcmp1_b32 s56, 18
    s_cbranch_scc1 L_ogokb1
    s_add_u32 s33, s52, 27648
    buffer_load_dwordx4 v[196:199], v5, s[28:31], s33 offen sc1
    s_add_u32 s33, s52, 36864
    buffer_load_dwordx4 v[200:203], v5, s[28:31], s33 offen sc1
    s_add_u32 s33, s52, 46080
    buffer_load_dwordx4 v[204:207], v5, s[28:31], s33 offen sc1
    s_waitcnt vmcnt(0)
    s_branch L_ogb1
L_ogokb1:
    ds_write_b128 v6, v[196:199] offset:12288
    ds_write_b128 v6, v[200:203] offset:16384
    ds_write_b128 v6, v[204:207] offset:20480
    s_mov_b32 s56, 0
    s_waitcnt vmcnt(0)
L_ogb2:
    v_max3_u32 v12, v208, v209, v210
    v_max3_u32 v12, v211, v212, v12
    v_max3_u32 v12, v213, v214, v12
    v_max3_u32 v12, v215, v216, v12
    v_max3_u32 v12, v217, v218, v12
    v_max_u32 v12, v219, v12
    v_cmp_eq_u32 vcc, -1, v12
    s_cbranch_vccz L_ogokb2
    s_add_u32 s56, s56, 1
    s_bitcmp1_b32 s56, 18
    s_cbranch_scc1 L_ogokb2
    s_add_u32 s33, s52, 55296
    buffer_load_dwordx4 v[208:211], v5, s[28:31], s33 offen sc1
    s_add_u32 s33, s52, 64512
    buffer_load_dwordx4 v[212:215], v5, s[28:31], s33 offen sc1
    buffer_load_dwordx4 v[216:219], v5, s[28:31], s53 offen sc1
    s_waitcnt vmcnt(0)
    s_branch L_ogb2
L_ogokb2:
    ds_write_b128 v6, v[208:211] offset:24576
    ds_write_b128 v6, v[212:215] offset:28672
    ds_write_b128 v7, v[216:219]
    s_waitcnt lgkmcnt(0)
    s_barrier
    s_lshl_b32 s35, s6, 5
    s_add_u32 s34, s59, s35
    s_add_u32 s35, s34, 18432
    s_add_u32 s33, s59, 18560
    ds_read_b128 v[220:223], v8 offset:256
    ds_read_b128 v[224:227], v8 offset:2304
    ds_read_b128 v[228:231], v8 offset:4352
    ds_read_b128 v[232:235], v8 offset:6400
    ds_read_b128 v[236:239], v8 offset:8448
    ds_read_b128 v[240:243], v8 offset:10496
    ds_read_b128 v[244:247], v8 offset:12544
    ds_read_b128 v[248:251], v8 offset:14592
    s_waitcnt lgkmcnt(7)
    v_mfma_f32_16x16x32_bf16 v[20:23], v[32:35], v[220:223], 0
    v_mfma_f32_16x16x32_bf16 v[24:27], v[104:107], v[220:223], 0
    ds_read_b128 v[220:223], v8 offset:16640
    s_waitcnt lgkmcnt(7)
    v_mfma_f32_16x16x32_bf16 v[20:23], v[36:39], v[224:227], v[20:23]
    v_mfma_f32_16x16x32_bf16 v[24:27], v[108:111], v[224:227], v[24:27]
    ds_read_b128 v[224:227], v8 offset:18688
    s_waitcnt lgkmcnt(7)
    v_mfma_f32_16x16x32_bf16 v[20:23], v[40:43], v[228:231], v[20:23]
    v_mfma_f32_16x16x32_bf16 v[24:27], v[112:115], v[228:231], v[24:27]
    ds_read_b128 v[228:231], v8 offset:20736
    s_waitcnt lgkmcnt(7)
    v_mfma_f32_16x16x32_bf16 v[20:23], v[44:47], v[232:235], v[20:23]
    v_mfma_f32_16x16x32_bf16 v[24:27], v[116:119], v[232:235], v[24:27]
    ds_read_b128 v[232:235], v8 offset:22784
    s_waitcnt lgkmcnt(7)
    v_mfma_f32_16x16x32_bf16 v[20:23], v[48:51], v[236:239], v[20:23]
    v_mfma_f32_16x16x32_bf16 v[24:27], v[120:123], v[236:239], v[24:27]
    ds_read_b128 v[236:239], v8 offset:24832
    s_waitcnt lgkmcnt(7)
    v_mfma_f32_16x16x32_bf16 v[20:23], v[52:55], v[240:243], v[20:23]
    v_mfma_f32_16x16x32_bf16 v[24:27], v[124:127], v[240:243], v[24:27]
    ds_read_b128 v[240:243], v8 offset:26880
    s_waitcnt lgkmcnt(7)
    v_mfma_f32_16x16x32_bf16 v[20:23], v[56:59], v[244:247], v[20:23]
    v_mfma_f32_16x16x32_bf16 v[24:27], v[128:131], v[244:247], v[24:27]
    ds_read_b128 v[244:247], v8 offset:28928
    s_waitcnt lgkmcnt(7)
    v_mfma_f32_16x16x32_bf16 v[20:23], v[60:63], v[248:251], v[20:23]
    v_mfma_f32_16x16x32_bf16 v[24:27], v[132:135], v[248:251], v[24:27]
    ds_read_b128 v[248:251], v8 offset:30976
    s_waitcnt lgkmcnt(7)
    v_mfma_f32_16x16x32_bf16 v[20:23], v[64:67], v[220:223], v[20:23]
    v_mfma_f32_16x16x32_bf16 v[24:27], v[136:139], v[220:223], v[24:27]
    ds_read_b128 v[220:223], v8 offset:33024
    s_waitcnt lgkmcnt(7)
    v_mfma_f32_16x16x32_bf16 v[20:23], v[68:71], v[224:227], v[20:23]
    v_mfma_f32_16x16x32_bf16 v[24:27], v[140:143], v[224:227], v[24:27]
    ds_read_b128 v[224:227], v8 offset:35072
    s_waitcnt lgkmcnt(7)
    v_mfma_f32_16x16x32_bf16 v[20:23], v[72:75], v[228:231], v[20:23]
    v_mfma_f32_16x16x32_bf16 v[24:27], v[144:147], v[228:231], v[24:27]
    ds_read_b128 v[228:231], v8 offset:0
    s_waitcnt lgkmcnt(7)
    v_mfma_f32_16x16x32_bf16 v[20:23], v[76:79], v[232:235], v[20:23]
    v_mfma_f32_16x16x32_bf16 v[24:27], v[148:151], v[232:235], v[24:27]
    ds_read_b128 v[232:235], v8 offset:2048
    s_waitcnt lgkmcnt(7)
    v_mfma_f32_16x16x32_bf16 v[20:23], v[80:83], v[236:239], v[20:23]
    v_mfma_f32_16x16x32_bf16 v[24:27], v[152:155], v[236:239], v[24:27]
    ds_read_b128 v[236:239], v8 offset:4096
    s_waitcnt lgkmcnt(7)
    v_mfma_f32_16x16x32_bf16 v[20:23], v[84:87], v[240:243], v[20:23]
    v_mfma_f32_16x16x32_bf16 v[24:27], v[156:159], v[240:243], v[24:27]
    ds_read_b128 v[240:243], v8 offset:6144
    s_waitcnt lgkmcnt(7)
    v_mfma_f32_16x16x32_bf16 v[20:23], v[88:91], v[244:247], v[20:23]
    v_mfma_f32_16x16x32_bf16 v[24:27], v[160:163], v[244:247], v[24:27]
    ds_read_b128 v[244:247], v8 offset:8192
    s_waitcnt lgkmcnt(7)
    v_mfma_f32_16x16x32_bf16 v[20:23], v[92:95], v[248:251], v[20:23]
    v_mfma_f32_16x16x32_bf16 v[24:27], v[164:167], v[248:251], v[24:27]
    ds_read_b128 v[248:251], v8 offset:10240
    s_waitcnt lgkmcnt(7)
    v_mfma_f32_16x16x32_bf16 v[20:23], v[96:99], v[220:223], v[20:23]
    v_mfma_f32_16x16x32_bf16 v[24:27], v[168:171], v[220:223], v[24:27]
    ds_read_b128 v[220:223], v8 offset:12288
    s_waitcnt lgkmcnt(7)
    v_mfma_f32_16x16x32_bf16 v[20:23], v[100:103], v[224:227], v[20:23]
    v_mfma_f32_16x16x32_bf16 v[24:27], v[172:175], v[224:227], v[24:27]
    ds_read_b128 v[224:227], v8 offset:14336
    s_waitcnt lgkmcnt(7)
    v_mfma_f32_16x16x32_bf16 v[16:19], v[32:35], v[228:231], 0
    ds_read_b128 v[228:231], v8 offset:16384
    s_waitcnt lgkmcnt(7)
    v_mfma_f32_16x16x32_bf16 v[16:19], v[36:39], v[232:235], v[16:19]
    ds_read_b128 v[232:235], v8 offset:18432
    s_waitcnt lgkmcnt(7)
    v_mfma_f32_16x16x32_bf16 v[16:19], v[40:43], v[236:239], v[16:19]
    ds_read_b128 v[236:239], v8 offset:20480
    s_waitcnt lgkmcnt(7)
    v_mfma_f32_16x16x32_bf16 v[16:19], v[44:47], v[240:243], v[16:19]
    ds_read_b128 v[240:243], v8 offset:22528
    v_cvt_pk_bf16_f32 v30, v20, v21
    v_cvt_pk_bf16_f32 v31, v22, v23
    buffer_store_dwordx2 v[30:31], v10, s[24:27], s35 offen
    v_cvt_pk_bf16_f32 v14, v24, v25
    v_cvt_pk_bf16_f32 v15, v26, v27
    s_mov_b32 exec_hi, 0
    buffer_store_dwordx2 v[14:15], v10, s[24:27], s33 offen
    s_mov_b32 exec_hi, -1
    s_waitcnt lgkmcnt(7)
    v_mfma_f32_16x16x32_bf16 v[16:19], v[48:51], v[244:247], v[16:19]
    ds_read_b128 v[244:247], v8 offset:24576
    s_waitcnt lgkmcnt(7)
    v_mfma_f32_16x16x32_bf16 v[16:19], v[52:55], v[248:251], v[16:19]
    ds_read_b128 v[248:251], v8 offset:26624
    s_waitcnt lgkmcnt(7)
    v_mfma_f32_16x16x32_bf16 v[16:19], v[56:59], v[220:223], v[16:19]
    ds_read_b128 v[220:223], v8 offset:28672
    s_waitcnt lgkmcnt(7)
    v_mfma_f32_16x16x32_bf16 v[16:19], v[60:63], v[224:227], v[16:19]
    ds_read_b128 v[224:227], v8 offset:30720
    s_waitcnt lgkmcnt(7)
    v_mfma_f32_16x16x32_bf16 v[16:19], v[64:67], v[228:231], v[16:19]
    ds_read_b128 v[228:231], v8 offset:32768
    s_waitcnt lgkmcnt(7)
    v_mfma_f32_16x16x32_bf16 v[16:19], v[68:71], v[232:235], v[16:19]
    ds_read_b128 v[232:235], v8 offset:34816
    s_waitcnt lgkmcnt(7)
    v_mfma_f32_16x16x32_bf16 v[16:19], v[72:75], v[236:239], v[16:19]
    s_waitcnt lgkmcnt(6)
    v_mfma_f32_16x16x32_bf16 v[16:19], v[76:79], v[240:243], v[16:19]
    s_waitcnt lgkmcnt(5)
    v_mfma_f32_16x16x32_bf16 v[16:19], v[80:83], v[244:247], v[16:19]
    s_waitcnt lgkmcnt(4)
    v_mfma_f32_16x16x32_bf16 v[16:19], v[84:87], v[248:251], v[16:19]
    s_waitcnt lgkmcnt(3)
    v_mfma_f32_16x16x32_bf16 v[16:19], v[88:91], v[220:223], v[16:19]
    s_waitcnt lgkmcnt(2)
    v_mfma_f32_16x16x32_bf16 v[16:19], v[92:95], v[224:227], v[16:19]
    s_waitcnt lgkmcnt(1)
    v_mfma_f32_16x16x32_bf16 v[16:19], v[96:99], v[228:231], v[16:19]
    s_waitcnt lgkmcnt(0)
    v_mfma_f32_16x16x32_bf16 v[16:19], v[100:103], v[232:235], v[16:19]
    s_nop 7
    v_cvt_pk_bf16_f32 v28, v16, v17
    v_cvt_pk_bf16_f32 v29, v18, v19
    buffer_store_dwordx2 v[28:29], v10, s[24:27], s34 offen
    s_endpgm
L_gplain:
    s_setprio 2
    s_add_u32 s33, s52, 0
    buffer_load_dwordx4 v[184:187], v5, s[28:31], s33 offen sc1
    s_add_u32 s33, s52, 9216
    buffer_load_dwordx4 v[188:191], v5, s[28:31], s33 offen sc1
    s_add_u32 s33, s52, 18432
    buffer_load_dwordx4 v[192:195], v5, s[28:31], s33 offen sc1
    s_setprio 1
    s_add_u32 s33, s52, 27648
    buffer_load_dwordx4 v[196:199], v5, s[28:31], s33 offen sc1
    s_add_u32 s33, s52, 36864
    buffer_load_dwordx4 v[200:203], v5, s[28:31], s33 offen sc1
    s_add_u32 s33, s52, 46080
    buffer_load_dwordx4 v[204:207], v5, s[28:31], s33 offen sc1
    s_setprio 0
    s_add_u32 s33, s52, 55296
    buffer_load_dwordx4 v[208:211], v5, s[28:31], s33 offen sc1
    s_add_u32 s33, s52, 64512
    buffer_load_dwordx4 v[212:215], v5, s[28:31], s33 offen sc1
    buffer_load_dwordx4 v[216:219], v5, s[28:31], s53 offen sc1
    s_waitcnt lgkmcnt(0)
    s_mov_b32 s56, 0
    s_waitcnt vmcnt(6)
L_ogc0:
    v_max3_u32 v12, v184, v185, v186
    v_max3_u32 v12, v187, v188, v12
    v_max3_u32 v12, v189, v190, v12
    v_max3_u32 v12, v191, v192, v12
    v_max3_u32 v12, v193, v194, v12
    v_max_u32 v12, v195, v12
    v_cmp_eq_u32 vcc, -1, v12
    s_cbranch_vccz L_ogokc0
    s_add_u32 s56, s56, 1
    s_bitcmp1_b32 s56, 18
    s_cbranch_scc1 L_ogokc0
    s_add_u32 s33, s52, 0
    buffer_load_dwordx4 v[184:187], v5, s[28:31], s33 offen sc1
    s_add_u32 s33, s52, 9216
    buffer_load_dwordx4 v[188:191], v5, s[28:31], s33 offen sc1
    s_add_u32 s33, s52, 18432
    buffer_load_dwordx4 v[192:195], v5, s[28:31], s33 offen sc1
    s_waitcnt vmcnt(0)
    s_branch L_ogc0
L_ogokc0:
    ds_write_b128 v6, v[184:187] offset:0
    ds_write_b128 v6, v[188:191] offset:4096
    ds_write_b128 v6, v[192:195] offset:8192
    s_mov_b32 s56, 0
    s_waitcnt vmcnt(3)
L_ogc1:
    v_max3_u32 v12, v196, v197, v198
    v_max3_u32 v12, v199, v200, v12
    v_max3_u32 v12, v201, v202, v12
    v_max3_u32 v12, v203, v204, v12
    v_max3_u32 v12, v205, v206, v12
    v_max_u32 v12, v207, v12
    v_cmp_eq_u32 vcc, -1, v12
    s_cbranch_vccz L_ogokc1
    s_add_u32 s56, s56, 1
    s_bitcmp1_b32 s56, 18
    s_cbranch_scc1 L_ogokc1
    s_add_u32 s33, s52, 27648
    buffer_load_dwordx4 v[196:199], v5, s[28:31], s33 offen sc1
    s_add_u32 s33, s52, 36864
    buffer_load_dwordx4 v[200:203], v5, s[28:31], s33 offen sc1
    s_add_u32 s33, s52, 46080
    buffer_load_dwordx4 v[204:207], v5, s[28:31], s33 offen sc1
    s_waitcnt vmcnt(0)
    s_branch L_ogc1
L_ogokc1:
    ds_write_b128 v6, v[196:199] offset:12288
    ds_write_b128 v6, v[200:203] offset:16384
    ds_write_b128 v6, v[204:207] offset:20480
    s_mov_b32 s56, 0
    s_waitcnt vmcnt(0)
L_ogc2:
    v_max3_u32 v12, v208, v209, v210
    v_max3_u32 v12, v211, v212, v12
    v_max3_u32 v12, v213, v214, v12
    v_max3_u32 v12, v215, v216, v12
    v_max3_u32 v12, v217, v218, v12
    v_max_u32 v12, v219, v12
    v_cmp_eq_u32 vcc, -1, v12
    s_cbranch_vccz L_ogokc2
    s_add_u32 s56, s56, 1
    s_bitcmp1_b32 s56, 18
    s_cbranch_scc1 L_ogokc2
    s_add_u32 s33, s52, 55296
    buffer_load_dwordx4 v[208:211], v5, s[28:31], s33 offen sc1
    s_add_u32 s33, s52, 64512
    buffer_load_dwordx4 v[212:215], v5, s[28:31], s33 offen sc1
    buffer_load_dwordx4 v[216:219], v5, s[28:31], s53 offen sc1
    s_waitcnt vmcnt(0)
    s_branch L_ogc2
L_ogokc2:
    ds_write_b128 v6, v[208:211] offset:24576
    ds_write_b128 v6, v[212:215] offset:28672
    ds_write_b128 v7, v[216:219]
    s_waitcnt lgkmcnt(0)
    s_barrier
    s_lshl_b32 s35, s6, 5
    s_add_u32 s34, s59, s35
    s_add_u32 s35, s34, 18432
    s_add_u32 s33, s59, 128
    ds_read_b128 v[220:223], v8 offset:0
    ds_read_b128 v[224:227], v8 offset:2048
    ds_read_b128 v[228:231], v8 offset:4096
    ds_read_b128 v[232:235], v8 offset:6144
    ds_read_b128 v[236:239], v8 offset:8192
    ds_read_b128 v[240:243], v8 offset:10240
    ds_read_b128 v[244:247], v8 offset:12288
    ds_read_b128 v[248:251], v8 offset:14336
    s_waitcnt lgkmcnt(7)
    v_mfma_f32_16x16x32_bf16 v[16:19], v[32:35], v[220:223], 0
    ds_read_b128 v[220:223], v8 offset:16384
    s_waitcnt lgkmcnt(7)
    v_mfma_f32_16x16x32_bf16 v[16:19], v[36:39], v[224:227], v[16:19]
    ds_read_b128 v[224:227], v8 offset:18432
    s_waitcnt lgkmcnt(7)
    v_mfma_f32_16x16x32_bf16 v[16:19], v[40:43], v[228:231], v[16:19]
    ds_read_b128 v[228:231], v8 offset:20480
    s_waitcnt lgkmcnt(7)
    v_mfma_f32_16x16x32_bf16 v[16:19], v[44:47], v[232:235], v[16:19]
    ds_read_b128 v[232:235], v8 offset:22528
    s_waitcnt lgkmcnt(7)
    v_mfma_f32_16x16x32_bf16 v[16:19], v[48:51], v[236:239], v[16:19]
    ds_read_b128 v[236:239], v8 offset:24576
    s_waitcnt lgkmcnt(7)
    v_mfma_f32_16x16x32_bf16 v[16:19], v[52:55], v[240:243], v[16:19]
    ds_read_b128 v[240:243], v8 offset:26624
    s_waitcnt lgkmcnt(7)
    v_mfma_f32_16x16x32_bf16 v[16:19], v[56:59], v[244:247], v[16:19]
    ds_read_b128 v[244:247], v8 offset:28672
    s_waitcnt lgkmcnt(7)
    v_mfma_f32_16x16x32_bf16 v[16:19], v[60:63], v[248:251], v[16:19]
    ds_read_b128 v[248:251], v8 offset:30720
    s_waitcnt lgkmcnt(7)
    v_mfma_f32_16x16x32_bf16 v[16:19], v[64:67], v[220:223], v[16:19]
    ds_read_b128 v[220:223], v8 offset:32768
    s_waitcnt lgkmcnt(7)
    v_mfma_f32_16x16x32_bf16 v[16:19], v[68:71], v[224:227], v[16:19]
    ds_read_b128 v[224:227], v8 offset:34816
    s_waitcnt lgkmcnt(7)
    v_mfma_f32_16x16x32_bf16 v[16:19], v[72:75], v[228:231], v[16:19]
    ds_read_b128 v[228:231], v8 offset:256
    s_waitcnt lgkmcnt(7)
    v_mfma_f32_16x16x32_bf16 v[16:19], v[76:79], v[232:235], v[16:19]
    ds_read_b128 v[232:235], v8 offset:2304
    s_waitcnt lgkmcnt(7)
    v_mfma_f32_16x16x32_bf16 v[16:19], v[80:83], v[236:239], v[16:19]
    ds_read_b128 v[236:239], v8 offset:4352
    s_waitcnt lgkmcnt(7)
    v_mfma_f32_16x16x32_bf16 v[16:19], v[84:87], v[240:243], v[16:19]
    ds_read_b128 v[240:243], v8 offset:6400
    s_waitcnt lgkmcnt(7)
    v_mfma_f32_16x16x32_bf16 v[16:19], v[88:91], v[244:247], v[16:19]
    ds_read_b128 v[244:247], v8 offset:8448
    s_waitcnt lgkmcnt(7)
    v_mfma_f32_16x16x32_bf16 v[16:19], v[92:95], v[248:251], v[16:19]
    ds_read_b128 v[248:251], v8 offset:10496
    s_waitcnt lgkmcnt(7)
    v_mfma_f32_16x16x32_bf16 v[16:19], v[96:99], v[220:223], v[16:19]
    ds_read_b128 v[220:223], v8 offset:12544
    s_waitcnt lgkmcnt(7)
    v_mfma_f32_16x16x32_bf16 v[16:19], v[100:103], v[224:227], v[16:19]
    ds_read_b128 v[224:227], v8 offset:14592
    s_waitcnt lgkmcnt(7)
    v_mfma_f32_16x16x32_bf16 v[20:23], v[32:35], v[228:231], 0
    ds_read_b128 v[228:231], v8 offset:16640
    s_waitcnt lgkmcnt(7)
    v_mfma_f32_16x16x32_bf16 v[20:23], v[36:39], v[232:235], v[20:23]
    ds_read_b128 v[232:235], v8 offset:18688
    s_waitcnt lgkmcnt(7)
    v_mfma_f32_16x16x32_bf16 v[20:23], v[40:43], v[236:239], v[20:23]
    ds_read_b128 v[236:239], v8 offset:20736
    s_waitcnt lgkmcnt(7)
    v_mfma_f32_16x16x32_bf16 v[20:23], v[44:47], v[240:243], v[20:23]
    ds_read_b128 v[240:243], v8 offset:22784
    v_cvt_pk_bf16_f32 v28, v16, v17
    v_cvt_pk_bf16_f32 v29, v18, v19
    buffer_store_dwordx2 v[28:29], v10, s[24:27], s34 offen
    s_waitcnt lgkmcnt(7)
    v_mfma_f32_16x16x32_bf16 v[20:23], v[48:51], v[244:247], v[20:23]
    ds_read_b128 v[244:247], v8 offset:24832
    s_waitcnt lgkmcnt(7)
    v_mfma_f32_16x16x32_bf16 v[20:23], v[52:55], v[248:251], v[20:23]
    ds_read_b128 v[248:251], v8 offset:26880
    s_waitcnt lgkmcnt(7)
    v_mfma_f32_16x16x32_bf16 v[20:23], v[56:59], v[220:223], v[20:23]
    ds_read_b128 v[220:223], v8 offset:28928
    s_waitcnt lgkmcnt(7)
    v_mfma_f32_16x16x32_bf16 v[20:23], v[60:63], v[224:227], v[20:23]
    ds_read_b128 v[224:227], v8 offset:30976
    s_waitcnt lgkmcnt(7)
    v_mfma_f32_16x16x32_bf16 v[20:23], v[64:67], v[228:231], v[20:23]
    ds_read_b128 v[228:231], v8 offset:33024
    s_waitcnt lgkmcnt(7)
    v_mfma_f32_16x16x32_bf16 v[20:23], v[68:71], v[232:235], v[20:23]
    ds_read_b128 v[232:235], v8 offset:35072
    s_waitcnt lgkmcnt(7)
    v_mfma_f32_16x16x32_bf16 v[20:23], v[72:75], v[236:239], v[20:23]
    s_waitcnt lgkmcnt(6)
    v_mfma_f32_16x16x32_bf16 v[20:23], v[76:79], v[240:243], v[20:23]
    s_waitcnt lgkmcnt(5)
    v_mfma_f32_16x16x32_bf16 v[20:23], v[80:83], v[244:247], v[20:23]
    s_waitcnt lgkmcnt(4)
    v_mfma_f32_16x16x32_bf16 v[20:23], v[84:87], v[248:251], v[20:23]
    s_waitcnt lgkmcnt(3)
    v_mfma_f32_16x16x32_bf16 v[20:23], v[88:91], v[220:223], v[20:23]
    s_waitcnt lgkmcnt(2)
    v_mfma_f32_16x16x32_bf16 v[20:23], v[92:95], v[224:227], v[20:23]
    s_waitcnt lgkmcnt(1)
    v_mfma_f32_16x16x32_bf16 v[20:23], v[96:99], v[228:231], v[20:23]
    s_waitcnt lgkmcnt(0)
    v_mfma_f32_16x16x32_bf16 v[20:23], v[100:103], v[232:235], v[20:23]
    s_nop 7
    v_cvt_pk_bf16_f32 v30, v20, v21
    v_cvt_pk_bf16_f32 v31, v22, v23
    buffer_store_dwordx2 v[30:31], v10, s[24:27], s35 offen
L_end_f:
L_exit_f:
    s_endpgm
L_codeend:
.set CODE_END, L_codeend
L_sfpoll:
    s_mov_b32 s56, 0
L_sfl:
    buffer_load_dwordx2 v[176:177], v180, s[28:31], s57 offen sc1
    s_add_u32 s56, s56, 1
    s_bitcmp1_b32 s56, 18
    s_waitcnt vmcnt(0)
    s_cbranch_scc1 L_sfok
    v_cmp_ne_u64 vcc, v[176:177], v[172:173]
    s_cbranch_vccnz L_sfl
    s_branch L_sfok
L_slow:
    v_mov_b32 v204, v136
    v_mov_b32 v205, 0
    s_mov_b32 exec_lo, 0
    v_mov_b32 v204, 0
    s_mov_b32 exec_lo, -1
    v_mov_b32 v213, 0
    v_mov_b32 v206, 0x7ffffff0
    v_cmp_gt_u32 vcc, 32, v1
    v_and_b32 v215, 31, v1
    v_lshrrev_b32 v214, 5, v1
    v_cndmask_b32 v207, v206, v5, vcc
    v_mul_u32_u24 v214, 304, v214
    v_cmp_gt_u32 vcc, 19, v215
    v_lshl_add_u32 v214, v215, 4, v214
    v_mov_b32 v216, 0xff7fffff
    v_cndmask_b32 v214, v206, v214, vcc
    s_mov_b32 s61, 0
    v_mov_b32 v96, 0
    v_mov_b32 v97, 0
    v_mov_b32 v98, 0
    v_mov_b32 v99, 0
    v_mov_b32 v100, 0
    v_mov_b32 v101, 0
    v_mov_b32 v102, 0
    v_mov_b32 v103, 0
    v_mov_b32 v104, 0
    v_mov_b32 v105, 0
    v_mov_b32 v106, 0
    v_mov_b32 v107, 0
    v_mov_b32 v108, 0
    v_mov_b32 v109, 0
    v_mov_b32 v110, 0
    v_mov_b32 v111, 0
L_slpass:
    s_mov_b32 s60, 0
L_sltile:
    s_lshr_b32 s62, s60, 3
    s_mul_i32 s62, s62, 19456
    s_and_b32 s63, s60, 7
    s_lshl_b32 s33, s63, 10
    s_add_u32 s33, s33, s62
    buffer_load_dwordx4 v[208:211], v5, s[28:31], s33 offen sc1
    s_and_b32 s33, s63, 1
    s_lshl_b32 s33, s33, 9
    s_lshr_b32 s32, s63, 1
    s_lshl_b32 s32, s32, 2
    s_add_u32 s33, s33, s32
    s_add_u32 s33, s33, s62
    s_add_u32 s33, s33, 8192
    buffer_load_dword v212, v207, s[28:31], s33 offen sc1
    s_mul_i32 s33, s63, 1216
    s_add_u32 s33, s33, s62
    s_add_u32 s33, s33, 9216
    buffer_load_dwordx4 v[220:223], v214, s[28:31], s33 offen sc1
    buffer_load_dwordx4 v[224:227], v214, s[28:31], s33 offen offset:608 sc1
    s_waitcnt vmcnt(0)
    v_mfma_f32_32x32x8_bf16 v[48:63], v[212:213], v[204:205], 0
    v_mfma_f32_32x32x16_bf16 v[48:63], v[208:211], v[128:131], v[48:63]
    s_nop 15
    s_cmp_lg_u32 s61, 0
    s_cbranch_scc1 L_slp2
    v_max3_f32 v216, v48, v49, v216
    v_max3_f32 v216, v50, v51, v216
    v_max3_f32 v216, v52, v53, v216
    v_max3_f32 v216, v54, v55, v216
    v_max3_f32 v216, v56, v57, v216
    v_max3_f32 v216, v58, v59, v216
    v_max3_f32 v216, v60, v61, v216
    v_max3_f32 v216, v62, v63, v216
    s_branch L_slnext
L_slp2:
    v_sub_f32 v48, v48, v216
    v_sub_f32 v49, v49, v216
    v_sub_f32 v50, v50, v216
    v_sub_f32 v51, v51, v216
    v_sub_f32 v52, v52, v216
    v_sub_f32 v53, v53, v216
    v_sub_f32 v54, v54, v216
    v_sub_f32 v55, v55, v216
    v_sub_f32 v56, v56, v216
    v_sub_f32 v57, v57, v216
    v_sub_f32 v58, v58, v216
    v_sub_f32 v59, v59, v216
    v_sub_f32 v60, v60, v216
    v_sub_f32 v61, v61, v216
    v_sub_f32 v62, v62, v216
    v_sub_f32 v63, v63, v216
    v_exp_f32 v48, v48
    v_exp_f32 v49, v49
    v_exp_f32 v50, v50
    v_exp_f32 v51, v51
    v_exp_f32 v52, v52
    v_exp_f32 v53, v53
    v_exp_f32 v54, v54
    v_exp_f32 v55, v55
    v_exp_f32 v56, v56
    v_exp_f32 v57, v57
    v_exp_f32 v58, v58
    v_exp_f32 v59, v59
    v_exp_f32 v60, v60
    v_exp_f32 v61, v61
    v_exp_f32 v62, v62
    v_exp_f32 v63, v63
    s_nop 0
    v_cvt_pk_bf16_f32 v80, v48, v49
    v_cvt_pk_bf16_f32 v81, v50, v51
    v_cvt_pk_bf16_f32 v82, v52, v53
    v_cvt_pk_bf16_f32 v83, v54, v55
    v_cvt_pk_bf16_f32 v84, v56, v57
    v_cvt_pk_bf16_f32 v85, v58, v59
    v_cvt_pk_bf16_f32 v86, v60, v61
    v_cvt_pk_bf16_f32 v87, v62, v63
    s_nop 1
    v_mfma_f32_32x32x16_bf16 v[96:111], v[220:223], v[80:83], v[96:111]
    v_mfma_f32_32x32x16_bf16 v[96:111], v[224:227], v[84:87], v[96:111]
    s_nop 7
L_slnext:
    s_add_u32 s60, s60, 1
    s_cmp_lt_u32 s60, 64
    s_cbranch_scc1 L_sltile
    s_cmp_lg_u32 s61, 0
    s_cbranch_scc1 L_sldone
    v_mov_b32 v217, v216
    v_mov_b32 v218, v216
    s_nop 1
    v_permlane32_swap_b32 v217, v218
    s_nop 1
    v_max3_f32 v216, v216, v217, v218
    s_mov_b32 s61, 1
    s_branch L_slpass
L_sldone:
    s_nop 15
    v_mov_b32 v16, v96
    v_mov_b32 v17, v97
    v_mov_b32 v18, v98
    v_mov_b32 v19, v99
    v_mov_b32 v20, v100
    v_mov_b32 v21, v101
    v_mov_b32 v22, v102
    v_mov_b32 v23, v103
    v_mov_b32 v24, v104
    v_mov_b32 v25, v105
    v_mov_b32 v26, v106
    v_mov_b32 v27, v26
    s_nop 1
    v_permlane32_swap_b32 v26, v27
    s_nop 1
    v_rcp_f32 v27, v26
    s_nop 0
    s_branch L_onorm
.section .rodata,"a"
.p2align 6
.amdhsa_kernel standalone__grouped_kv_mqa__prompt_kernel
  .amdhsa_next_free_vgpr 256
  .amdhsa_next_free_sgpr 96
  .amdhsa_accum_offset 256
  .amdhsa_group_segment_fixed_size 0
  .amdhsa_kernarg_size 64
  .amdhsa_user_sgpr_count 2
  .amdhsa_user_sgpr_kernarg_segment_ptr 1
  .amdhsa_system_sgpr_workgroup_id_x 1
.end_amdhsa_kernel
```
